```python
import torch

def _softmax(x, axis=-1):
    return torch.softmax(x, dim=axis)
def _gelu(x):
    return torch.nn.functional.gelu(x, approximate="tanh")
def _silu(x):
    return torch.nn.functional.silu(x)
def _sigmoid(x):
    return torch.sigmoid(x)
def _layernorm(x, axis=-1, eps=1e-5):
    m = x.mean(dim=axis, keepdim=True)
    v = x.var(dim=axis, keepdim=True, unbiased=False)
    return (x - m) / torch.sqrt(v + eps)
def _scatter_add(tgt, idx, src, axis=0):
    return tgt.clone().index_add_(axis, idx, src)
def _segment_sum(src, seg, n):
    out = torch.zeros((n,) + src.shape[1:], dtype=src.dtype)
    return out.index_add_(0, seg, src)
def _pad(x, pw):
    flat = tuple(v for pair in reversed(pw) for v in pair)
    return torch.nn.functional.pad(x, flat)

kernel_name = 'sequential_preLN__ssm_conv_h3__dense_activation_gelu__prompt'

def setup_inputs():

    _w = (lambda a: (lambda t: t.to(torch.bfloat16) if t.is_floating_point() else t)(torch.as_tensor(a)))
    def _A_setup():
        B, S, D = 1, 2048, 640
        ks = 4
        return {
            "q": _w((lambda *s: torch.randn(*s, dtype=torch.bfloat16) * 0.05)(B, S, D)),
            "k": _w((lambda *s: torch.randn(*s, dtype=torch.bfloat16) * 0.2)(B, S, D)),
            "v": _w((lambda *s: torch.randn(*s, dtype=torch.bfloat16) * 0.2)(B, S, D)),
            "shift_k": _w((lambda *s: torch.randn(*s, dtype=torch.bfloat16) * 0.2)(D, ks) * 0.5),
            "ssm_k": _w((lambda *s: torch.randn(*s, dtype=torch.bfloat16) * 0.8)(D, S) * (1.0 / S ** 0.5)),
            "ssm_D": _w((lambda *s: torch.randn(*s, dtype=torch.bfloat16) * 0.2)(D)),
        }
    _A_in = _A_setup()

    def _B_setup():
        B, S, D, F = 1, 2048, 640, 1536
        return {
            "x": _w((lambda *s: torch.randn(*s, dtype=torch.bfloat16) * 0.05)(B, S, D)),
            "w1": _w((lambda *s: torch.randn(*s, dtype=torch.bfloat16) * 0.4)(D, F) * (D ** -0.5)),
            "b1": _w((lambda *s: torch.randn(*s, dtype=torch.bfloat16) * 12.8)(F) * 0.01),
            "w2": _w((lambda *s: torch.randn(*s, dtype=torch.bfloat16) * 0.2)(F, D) * (F ** -0.5)),
            "b2": _w((lambda *s: torch.randn(*s, dtype=torch.bfloat16) * 3.2)(D) * 0.01),
        }
    _B_in = _B_setup()

    return {
        "A_q": _A_in["q"],
        "A_k": _A_in["k"],
        "A_v": _A_in["v"],
        "A_shift_k": _A_in["shift_k"],
        "A_ssm_k": _A_in["ssm_k"],
        "A_ssm_D": _A_in["ssm_D"],
        "B_x": _B_in["x"],
        "B_w1": _B_in["w1"],
        "B_b1": _B_in["b1"],
        "B_w2": _B_in["w2"],
        "B_b2": _B_in["b2"],
    }

def reference(A_q, A_k, A_v, A_shift_k, A_ssm_k, A_ssm_D, B_x, B_w1, B_b1, B_w2, B_b2):
    def _A_ref(q, k, v, shift_k, ssm_k, ssm_D):
        B, S, D = q.shape
        ks = shift_k.shape[-1]
        k_pad = _pad(k, ((0, 0), (ks - 1, 0), (0, 0)))
        k_shift = torch.zeros_like(k)
        for t in range(ks):
            k_shift = k_shift + k_pad[:, t:t + S, :] * shift_k[:, ks - 1 - t][None, None, :]
        kv = k_shift * v
        L = 2 * S
        kv_pad = _pad(kv, ((0, 0), (0, S), (0, 0)))
        kf_pad = _pad(ssm_k, ((0, 0), (0, S)))
        kv_f = (lambda x, axes=(-2,-1): torch.fft.rfft2(x.float(), dim=axes))(kv_pad[:, None, :, :], axes=(1, 2))
        kf_f = (lambda x, axes=(-2,-1): torch.fft.rfft2(x.float(), dim=axes))(kf_pad[:, None, :], axes=(1, 2))
        kf_f = (lambda x, *d: x.permute(*d))(kf_f, 1, 2, 0)
        y_f = kv_f * kf_f[None, :, :, :]
        y = (lambda x, s, axes=(-2,-1): torch.fft.irfft2(x, s=s, dim=axes).to(torch.bfloat16))(y_f, (1, L), axes=(1, 2))[:, 0, :S, :]
        y = y + kv * ssm_D[None, None, :]
        return q * y

    def _B_ref(x, w1, b1, w2, b2):
        h = torch.einsum("bsd,df->bsf", x, w1) + b1
        h = _gelu(h)
        return torch.einsum("bsf,fd->bsd", h, w2) + b2

    x = A_q
    h = x + _A_ref(_layernorm(x, axis=-1), A_k, A_v, A_shift_k, A_ssm_k, A_ssm_D)
    h2 = h + _B_ref(_layernorm(h, axis=-1), B_w1, B_b1, B_w2, B_b2)
    return h2
```

```asm
; @launch kernel=ka_kernel grid=(640,1,1) block=(256,1,1) lds=45824
; @launch kernel=kb_kernel grid=(256,1,1) block=(512,1,1) lds=163840
.amdgcn_target "amdgcn-amd-amdhsa--gfx950"
.text
.globl ka_kernel
.p2align 8
.type ka_kernel,@function
ka_kernel:
  s_cmp_ge_u32 s2, 640
  s_cbranch_scc1 KA_END
  s_mov_b32 s62, s2
  s_mov_b32 s100, s2
  s_cmp_ge_u32 s2, 256
  s_cselect_b32 s101, 64, 0
  s_add_u32 s100, s2, s101
  s_cmp_ge_u32 s2, 448
  s_cbranch_scc0 KA_RM
  s_sub_u32 s100, s2, 192
  s_cmp_ge_u32 s2, 512
  s_cselect_b32 s100, s2, s100
KA_RM:
  s_load_dwordx4 s[4:7], s[0:1], 0
  s_load_dwordx4 s[72:75], s[0:1], 16
  s_load_dwordx4 s[40:43], s[0:1], 32
  s_load_dwordx2 s[8:9], s[0:1], 104
  s_load_dwordx2 s[50:51], s[0:1], 56
  s_load_dwordx2 s[52:53], s[0:1], 72
  v_and_b32 v1, 63, v0
  v_lshrrev_b32 v2, 6, v0
  s_nop 0
  v_readfirstlane_b32 s33, v2
  s_lshl_b32 s36, s2, 12
  s_lshl_b32 s37, s33, 10
  s_add_u32 s38, s36, s37
  v_lshl_add_u32 v119, v1, 4, s38
  s_lshl_b32 s39, s2, 1
  s_and_b32 s39, s39, 0xfffffffc
  s_mov_b32 s10, 8028160
  s_cmp_ge_u32 s100, 320
  s_cbranch_scc1 KA_NOTILE
  s_setprio 2
  s_mul_hi_u32 s60, s100, 0x1999999a
  s_mul_i32 s63, s60, 10
  s_sub_u32 s63, s100, s63
  s_mul_i32 s61, s63, 256
  s_add_u32 s61, s61, s60
  v_and_b32 v3, 31, v1
  v_lshrrev_b32 v4, 5, v1
  v_lshl_add_u32 v4, v2, 1, v4
  s_lshl_b32 s63, s63, 6
  v_lshl_add_u32 v5, v3, 1, s63
  s_lshl_b32 s60, s60, 6
  v_lshl_add_u32 v6, v4, 3, s60
  s_movk_i32 s54, 1280
  v_mul_lo_u32 v7, v6, s54
  v_lshl_add_u32 v7, v5, 1, v7
  v_subrev_u32 v8, 3840, v7
  v_lshlrev_b32 v9, 3, v5
  v_and_b32 v37, 7, v3
  v_xor_b32 v37, v37, v4
  v_lshlrev_b32 v37, 4, v37
  v_lshl_add_u32 v37, v3, 8, v37
  v_add_u32 v37, 21248, v37
  v_lshrrev_b32 v38, 3, v1
  v_lshl_add_u32 v38, v2, 3, v38
  v_and_b32 v39, 7, v1
  v_bfe_u32 v116, v38, 1, 3
  v_xor_b32 v116, v116, v39
  v_lshlrev_b32 v116, 4, v116
  v_lshl_add_u32 v116, v38, 7, v116
  v_add_u32 v116, 21248, v116
  v_add_u32 v117, s63, v38
  v_lshlrev_b32 v117, 12, v117
  v_lshl_add_u32 v117, v39, 4, v117
  s_lshl_b32 s54, s60, 1
  v_add_u32 v117, s54, v117
  s_movk_i32 s55, 5120
  v_lshrrev_b32 v8, 3, v1
  v_lshl_add_u32 v8, v2, 3, v8
  v_add_u32 v8, s60, v8
  v_subrev_u32 v8, 3, v8
  s_movk_i32 s10, 1280
  v_mul_i32_i24 v8, 1280, v8
  v_and_b32 v7, 7, v1
  v_lshl_add_u32 v8, v7, 4, v8
  s_lshl_b32 s10, s63, 1
  v_add_u32 v8, s10, v8
  v_add_u32 v7, 40960, v8
  v_add_u32 v6, 81920, v8
  v_add_u32 v10, 3840, v8
  v_add_u32 v11, 3840, v7
  v_lshlrev_b32 v126, 10, v4
  v_lshl_add_u32 v126, v3, 2, v126
  v_add_u32 v127, 37632, v126
  s_mov_b32 s10, 8028160
  s_waitcnt lgkmcnt(0)
  s_mov_b32 s68, s6
  s_and_b32 s69, s7, 0xffff
  s_mov_b32 s70, 2621440
  s_mov_b32 s71, 0x20000
  s_lshl_b32 s54, s33, 10
  s_mov_b32 m0, s54
  s_add_u32 s55, s54, 4096
  buffer_load_dwordx4 v8, s[68:71], 0 offen lds
  s_mov_b32 m0, s55
  s_nop 0
  buffer_load_dwordx4 v7, s[68:71], 0 offen lds
  s_cmp_eq_u32 s33, 0
  s_cbranch_scc0 KA_K8
  s_movk_i32 s55, 8192
  s_mov_b32 m0, s55
  s_nop 0
  buffer_load_dwordx4 v6, s[68:71], 0 offen lds
KA_K8:
  s_mov_b32 s76, s74
  s_and_b32 s77, s75, 0xffff
  s_mov_b32 s78, 5120
  s_mov_b32 s79, 0x20000
  s_mov_b32 s72, s72
  s_and_b32 s73, s73, 0xffff
  s_mov_b32 s74, 2621440
  s_mov_b32 s75, 0x20000
  s_add_u32 s54, s54, 37632
  s_mov_b32 m0, s54
  s_add_u32 s55, s54, 4096
  buffer_load_dwordx4 v10, s[72:75], 0 offen lds
  s_mov_b32 m0, s55
  s_nop 0
  buffer_load_dwordx4 v11, s[72:75], 0 offen lds
  buffer_load_dwordx4 v[40:43], v9, s[76:79], 0 offen
  s_mov_b32 s64, s4
  s_and_b32 s65, s5, 0xffff
  s_mov_b32 s66, 2621440
  s_mov_b32 s67, 0x20000
  s_load_dword s11, s[8:9], s10
  s_load_dword s34, s[42:43], s39
  s_mov_b32 s12, s40
  s_and_b32 s13, s41, 0xffff
  s_mov_b32 s14, 2621440
  s_mov_b32 s15, 0x20000
  buffer_load_dwordx4 v[120:123], v119, s[12:15], 0 offen
  s_mov_b32 exec_lo, 0x80008000
  s_mov_b32 exec_hi, 0x80008000
  buffer_load_dwordx2 v[124:125], v119, s[12:15], 0 offen offset:16
  s_mov_b64 exec, -1
  s_add_u32 s16, s8, 0
  s_addc_u32 s17, s9, 0
  s_and_b32 s17, s17, 0xffff
  s_mov_b32 s18, 2621440
  s_mov_b32 s19, 0x20000
  s_add_u32 s20, s8, 2621440
  s_addc_u32 s21, s9, 0
  s_and_b32 s21, s21, 0xffff
  s_mov_b32 s22, 2621440
  s_mov_b32 s23, 0x20000
  s_add_u32 s24, s8, 7864320
  s_addc_u32 s25, s9, 0
  s_and_b32 s25, s25, 0xffff
  s_mov_b32 s26, 16384
  s_mov_b32 s27, 0x20000
  s_add_u32 s28, s8, 5242880
  s_addc_u32 s29, s9, 0
  s_and_b32 s29, s29, 0xffff
  s_mov_b32 s30, 2621440
  s_mov_b32 s31, 0x20000
  s_add_u32 s96, s8, 7995392
  s_addc_u32 s97, s9, 0
  s_and_b32 s97, s97, 0xffff
  s_mov_b32 s98, 12800
  s_mov_b32 s99, 0x20000
  v_mov_b32 v38, v10
  v_mov_b32 v39, v11
  s_mov_b32 s45, 0x05040100
  s_mov_b32 s46, 0x07060302
  s_waitcnt vmcnt(2)
  s_barrier
  ds_read_b32 v10, v126 offset:0
  ds_read_b32 v11, v126 offset:128
  ds_read_b32 v12, v126 offset:256
  ds_read_b32 v13, v126 offset:384
  ds_read_b32 v14, v126 offset:512
  ds_read_b32 v15, v126 offset:640
  ds_read_b32 v16, v126 offset:768
  ds_read_b32 v17, v126 offset:896
  ds_read_b32 v18, v126 offset:1024
  ds_read_b32 v19, v126 offset:1152
  ds_read_b32 v20, v126 offset:1280
  ds_read_b32 v21, v127 offset:0
  ds_read_b32 v22, v127 offset:128
  ds_read_b32 v23, v127 offset:256
  ds_read_b32 v24, v127 offset:384
  ds_read_b32 v25, v127 offset:512
  ds_read_b32 v26, v127 offset:640
  ds_read_b32 v27, v127 offset:768
  ds_read_b32 v28, v127 offset:896
  s_waitcnt lgkmcnt(8)
  v_lshlrev_b32 v44, 16, v40
  v_lshlrev_b32 v45, 16, v42
  v_and_b32 v46, 0xffff0000, v40
  v_and_b32 v47, 0xffff0000, v42
  v_lshlrev_b32 v48, 16, v41
  v_lshlrev_b32 v49, 16, v43
  v_and_b32 v50, 0xffff0000, v41
  v_and_b32 v51, 0xffff0000, v43
  v_lshlrev_b32 v52, 16, v10
  v_and_b32 v53, 0xffff0000, v10
  v_lshlrev_b32 v54, 16, v11
  v_and_b32 v55, 0xffff0000, v11
  v_lshlrev_b32 v56, 16, v12
  v_and_b32 v57, 0xffff0000, v12
  v_lshlrev_b32 v58, 16, v13
  v_and_b32 v59, 0xffff0000, v13
  v_lshlrev_b32 v60, 16, v14
  v_and_b32 v61, 0xffff0000, v14
  v_lshlrev_b32 v62, 16, v15
  v_and_b32 v63, 0xffff0000, v15
  v_lshlrev_b32 v64, 16, v16
  v_and_b32 v65, 0xffff0000, v16
  v_lshlrev_b32 v66, 16, v17
  v_and_b32 v67, 0xffff0000, v17
  v_lshlrev_b32 v68, 16, v18
  v_and_b32 v69, 0xffff0000, v18
  v_lshlrev_b32 v70, 16, v19
  v_and_b32 v71, 0xffff0000, v19
  v_lshlrev_b32 v72, 16, v20
  v_and_b32 v73, 0xffff0000, v20
  v_pk_mul_f32 v[80:81], v[44:45], v[58:59]
  v_pk_fma_f32 v[80:81], v[46:47], v[56:57], v[80:81]
  v_pk_fma_f32 v[80:81], v[48:49], v[54:55], v[80:81]
  v_pk_fma_f32 v[80:81], v[50:51], v[52:53], v[80:81]
  v_pk_mul_f32 v[82:83], v[44:45], v[60:61]
  v_pk_fma_f32 v[82:83], v[46:47], v[58:59], v[82:83]
  v_pk_fma_f32 v[82:83], v[48:49], v[56:57], v[82:83]
  v_pk_fma_f32 v[82:83], v[50:51], v[54:55], v[82:83]
  v_pk_mul_f32 v[84:85], v[44:45], v[62:63]
  v_pk_fma_f32 v[84:85], v[46:47], v[60:61], v[84:85]
  v_pk_fma_f32 v[84:85], v[48:49], v[58:59], v[84:85]
  v_pk_fma_f32 v[84:85], v[50:51], v[56:57], v[84:85]
  v_pk_mul_f32 v[86:87], v[44:45], v[64:65]
  v_pk_fma_f32 v[86:87], v[46:47], v[62:63], v[86:87]
  v_pk_fma_f32 v[86:87], v[48:49], v[60:61], v[86:87]
  v_pk_fma_f32 v[86:87], v[50:51], v[58:59], v[86:87]
  v_pk_mul_f32 v[88:89], v[44:45], v[66:67]
  v_pk_fma_f32 v[88:89], v[46:47], v[64:65], v[88:89]
  v_pk_fma_f32 v[88:89], v[48:49], v[62:63], v[88:89]
  v_pk_fma_f32 v[88:89], v[50:51], v[60:61], v[88:89]
  v_pk_mul_f32 v[90:91], v[44:45], v[68:69]
  v_pk_fma_f32 v[90:91], v[46:47], v[66:67], v[90:91]
  v_pk_fma_f32 v[90:91], v[48:49], v[64:65], v[90:91]
  v_pk_fma_f32 v[90:91], v[50:51], v[62:63], v[90:91]
  v_pk_mul_f32 v[92:93], v[44:45], v[70:71]
  v_pk_fma_f32 v[92:93], v[46:47], v[68:69], v[92:93]
  v_pk_fma_f32 v[92:93], v[48:49], v[66:67], v[92:93]
  v_pk_fma_f32 v[92:93], v[50:51], v[64:65], v[92:93]
  v_pk_mul_f32 v[94:95], v[44:45], v[72:73]
  v_pk_fma_f32 v[94:95], v[46:47], v[70:71], v[94:95]
  v_pk_fma_f32 v[94:95], v[48:49], v[68:69], v[94:95]
  v_pk_fma_f32 v[94:95], v[50:51], v[66:67], v[94:95]
  s_waitcnt lgkmcnt(0)
  v_lshlrev_b32 v76, 16, v21
  v_and_b32 v77, 0xffff0000, v21
  v_pk_mul_f32 v[80:81], v[80:81], v[76:77]
  v_lshlrev_b32 v76, 16, v22
  v_and_b32 v77, 0xffff0000, v22
  v_pk_mul_f32 v[82:83], v[82:83], v[76:77]
  v_lshlrev_b32 v76, 16, v23
  v_and_b32 v77, 0xffff0000, v23
  v_pk_mul_f32 v[84:85], v[84:85], v[76:77]
  v_lshlrev_b32 v76, 16, v24
  v_and_b32 v77, 0xffff0000, v24
  v_pk_mul_f32 v[86:87], v[86:87], v[76:77]
  v_lshlrev_b32 v76, 16, v25
  v_and_b32 v77, 0xffff0000, v25
  v_pk_mul_f32 v[88:89], v[88:89], v[76:77]
  v_lshlrev_b32 v76, 16, v26
  v_and_b32 v77, 0xffff0000, v26
  v_pk_mul_f32 v[90:91], v[90:91], v[76:77]
  v_lshlrev_b32 v76, 16, v27
  v_and_b32 v77, 0xffff0000, v27
  v_pk_mul_f32 v[92:93], v[92:93], v[76:77]
  v_lshlrev_b32 v76, 16, v28
  v_and_b32 v77, 0xffff0000, v28
  v_pk_mul_f32 v[94:95], v[94:95], v[76:77]
  v_cvt_pk_bf16_f32 v100, v80, v82
  v_cvt_pk_bf16_f32 v104, v81, v83
  v_cvt_pk_bf16_f32 v101, v84, v86
  v_cvt_pk_bf16_f32 v105, v85, v87
  v_cvt_pk_bf16_f32 v102, v88, v90
  v_cvt_pk_bf16_f32 v106, v89, v91
  v_cvt_pk_bf16_f32 v103, v92, v94
  v_cvt_pk_bf16_f32 v107, v93, v95
  ds_write_b128 v37, v[100:103]
  ds_write_b128 v37, v[104:107] offset:128
  s_mov_b32 s43, 0x20000
  s_waitcnt lgkmcnt(0)
  s_barrier
  ds_read_b128 v[80:83], v116 offset:0
  ds_read_b128 v[84:87], v116 offset:4096
  s_waitcnt lgkmcnt(0)
  buffer_store_dwordx4 v[80:83], v117, s[16:19], 0 offen sc1
  buffer_store_dwordx4 v[84:87], v117, s[16:19], s43 offen sc1
  s_lshl_b32 s54, s33, 10
  s_add_u32 s54, s54, 37632
  s_mov_b32 m0, s54
  s_add_u32 s55, s54, 4096
  buffer_load_dwordx4 v38, s[64:67], 0 offen lds
  s_mov_b32 m0, s55
  s_nop 0
  buffer_load_dwordx4 v39, s[64:67], 0 offen lds
  v_mov_b32 v38, v127
  s_waitcnt vmcnt(4)
  s_branch KA_JOIN
KA_NOTILE:
  v_mov_b32 v37, 0
  v_mov_b32 v38, 0
  v_mov_b32 v116, 0
  v_mov_b32 v117, 0
  s_waitcnt lgkmcnt(0)
  s_load_dword s11, s[8:9], s10
  s_load_dword s34, s[42:43], s39
  s_mov_b32 s12, s40
  s_and_b32 s13, s41, 0xffff
  s_mov_b32 s14, 2621440
  s_mov_b32 s15, 0x20000
  buffer_load_dwordx4 v[120:123], v119, s[12:15], 0 offen
  s_mov_b32 exec_lo, 0x80008000
  s_mov_b32 exec_hi, 0x80008000
  buffer_load_dwordx2 v[124:125], v119, s[12:15], 0 offen offset:16
  s_mov_b64 exec, -1
  s_add_u32 s16, s8, 0
  s_addc_u32 s17, s9, 0
  s_and_b32 s17, s17, 0xffff
  s_mov_b32 s18, 2621440
  s_mov_b32 s19, 0x20000
  s_add_u32 s20, s8, 2621440
  s_addc_u32 s21, s9, 0
  s_and_b32 s21, s21, 0xffff
  s_mov_b32 s22, 2621440
  s_mov_b32 s23, 0x20000
  s_add_u32 s24, s8, 7864320
  s_addc_u32 s25, s9, 0
  s_and_b32 s25, s25, 0xffff
  s_mov_b32 s26, 16384
  s_mov_b32 s27, 0x20000
  s_add_u32 s28, s8, 5242880
  s_addc_u32 s29, s9, 0
  s_and_b32 s29, s29, 0xffff
  s_mov_b32 s30, 2621440
  s_mov_b32 s31, 0x20000
  s_add_u32 s96, s8, 7995392
  s_addc_u32 s97, s9, 0
  s_and_b32 s97, s97, 0xffff
  s_mov_b32 s98, 12800
  s_mov_b32 s99, 0x20000
  s_cmp_ge_u32 s100, 448
  s_cbranch_scc1 KA_NONE
  s_mov_b32 s64, s4
  s_and_b32 s65, s5, 0xffff
  s_mov_b32 s66, 2621440
  s_mov_b32 s67, 0x20000
KA_STAT:
  s_add_u32 s61, s100, 2240
  s_sub_u32 s54, s100, 320
  s_and_b32 s55, s54, 15
  s_lshr_b32 s54, s54, 4
  s_mov_b32 s56, s52
  s_and_b32 s57, s53, 0xffff
  s_mov_b32 s58, 1966080
  s_mov_b32 s59, 0x20000
  s_mul_i32 s60, s55, 122880
  s_mul_i32 s63, s54, 160
  s_add_u32 s60, s60, s63
  v_add_u32 v100, 0, v0
  s_mov_b32 s63, 0x1999999a
  v_mul_hi_u32 v101, v100, s63
  v_mul_u32_u24 v102, 10, v101
  v_sub_u32 v102, v100, v102
  v_mul_u32_u24 v103, 1280, v101
  v_lshl_add_u32 v103, v102, 4, v103
  buffer_load_dwordx4 v[144:147], v103, s[56:59], s60 offen
  v_add_u32 v100, 256, v0
  s_mov_b32 s63, 0x1999999a
  v_mul_hi_u32 v101, v100, s63
  v_mul_u32_u24 v102, 10, v101
  v_sub_u32 v102, v100, v102
  v_mul_u32_u24 v103, 1280, v101
  v_lshl_add_u32 v103, v102, 4, v103
  buffer_load_dwordx4 v[148:151], v103, s[56:59], s60 offen
  v_add_u32 v100, 512, v0
  s_mov_b32 s63, 0x1999999a
  v_mul_hi_u32 v101, v100, s63
  v_mul_u32_u24 v102, 10, v101
  v_sub_u32 v102, v100, v102
  v_mul_u32_u24 v103, 1280, v101
  v_lshl_add_u32 v103, v102, 4, v103
  buffer_load_dwordx4 v[152:155], v103, s[56:59], s60 offen
  v_add_u32 v100, 768, v0
  s_mov_b32 s63, 0x1999999a
  v_mul_hi_u32 v101, v100, s63
  v_mul_u32_u24 v102, 10, v101
  v_sub_u32 v102, v100, v102
  v_mul_u32_u24 v103, 1280, v101
  v_lshl_add_u32 v103, v102, 4, v103
  buffer_load_dwordx4 v[156:159], v103, s[56:59], s60 offen
  s_sub_u32 s40, s100, 320
  s_lshl_b32 s40, s40, 4
  v_lshrrev_b32 v3, 4, v1
  v_lshl_add_u32 v3, v2, 2, v3
  v_add_u32 v3, s40, v3
  v_and_b32 v4, 15, v1
  s_movk_i32 s42, 1280
  v_mul_lo_u32 v5, v3, s42
  v_lshl_add_u32 v5, v4, 4, v5
  buffer_load_dwordx4 v[8:11], v5, s[64:67], 0 offen offset:0
  buffer_load_dwordx4 v[12:15], v5, s[64:67], 0 offen offset:256
  buffer_load_dwordx4 v[16:19], v5, s[64:67], 0 offen offset:512
  buffer_load_dwordx4 v[20:23], v5, s[64:67], 0 offen offset:768
  buffer_load_dwordx4 v[24:27], v5, s[64:67], 0 offen offset:1024
  s_waitcnt vmcnt(0)
  v_lshlrev_b32 v32, 16, v8
  v_and_b32 v33, 0xffff0000, v8
  v_lshlrev_b32 v34, 16, v9
  v_and_b32 v35, 0xffff0000, v9
  v_lshlrev_b32 v36, 16, v10
  v_and_b32 v37, 0xffff0000, v10
  v_lshlrev_b32 v38, 16, v11
  v_and_b32 v39, 0xffff0000, v11
  v_lshlrev_b32 v40, 16, v12
  v_and_b32 v41, 0xffff0000, v12
  v_lshlrev_b32 v42, 16, v13
  v_and_b32 v43, 0xffff0000, v13
  v_lshlrev_b32 v44, 16, v14
  v_and_b32 v45, 0xffff0000, v14
  v_lshlrev_b32 v46, 16, v15
  v_and_b32 v47, 0xffff0000, v15
  v_lshlrev_b32 v48, 16, v16
  v_and_b32 v49, 0xffff0000, v16
  v_lshlrev_b32 v50, 16, v17
  v_and_b32 v51, 0xffff0000, v17
  v_lshlrev_b32 v52, 16, v18
  v_and_b32 v53, 0xffff0000, v18
  v_lshlrev_b32 v54, 16, v19
  v_and_b32 v55, 0xffff0000, v19
  v_lshlrev_b32 v56, 16, v20
  v_and_b32 v57, 0xffff0000, v20
  v_lshlrev_b32 v58, 16, v21
  v_and_b32 v59, 0xffff0000, v21
  v_lshlrev_b32 v60, 16, v22
  v_and_b32 v61, 0xffff0000, v22
  v_lshlrev_b32 v62, 16, v23
  v_and_b32 v63, 0xffff0000, v23
  v_lshlrev_b32 v64, 16, v24
  v_and_b32 v65, 0xffff0000, v24
  v_lshlrev_b32 v66, 16, v25
  v_and_b32 v67, 0xffff0000, v25
  v_lshlrev_b32 v68, 16, v26
  v_and_b32 v69, 0xffff0000, v26
  v_lshlrev_b32 v70, 16, v27
  v_and_b32 v71, 0xffff0000, v27
  v_pk_add_f32 v[72:73], v[32:33], v[34:35]
  v_pk_add_f32 v[72:73], v[72:73], v[36:37]
  v_pk_add_f32 v[72:73], v[72:73], v[38:39]
  v_pk_add_f32 v[72:73], v[72:73], v[40:41]
  v_pk_add_f32 v[72:73], v[72:73], v[42:43]
  v_pk_add_f32 v[72:73], v[72:73], v[44:45]
  v_pk_add_f32 v[72:73], v[72:73], v[46:47]
  v_pk_add_f32 v[72:73], v[72:73], v[48:49]
  v_pk_add_f32 v[72:73], v[72:73], v[50:51]
  v_pk_add_f32 v[72:73], v[72:73], v[52:53]
  v_pk_add_f32 v[72:73], v[72:73], v[54:55]
  v_pk_add_f32 v[72:73], v[72:73], v[56:57]
  v_pk_add_f32 v[72:73], v[72:73], v[58:59]
  v_pk_add_f32 v[72:73], v[72:73], v[60:61]
  v_pk_add_f32 v[72:73], v[72:73], v[62:63]
  v_pk_add_f32 v[72:73], v[72:73], v[64:65]
  v_pk_add_f32 v[72:73], v[72:73], v[66:67]
  v_pk_add_f32 v[72:73], v[72:73], v[68:69]
  v_pk_add_f32 v[72:73], v[72:73], v[70:71]
  v_add_f32 v72, v72, v73
  s_nop 1
  v_add_f32_dpp v72, v72, v72 row_ror:8 row_mask:0xf bank_mask:0xf
  s_nop 1
  v_add_f32_dpp v72, v72, v72 row_ror:4 row_mask:0xf bank_mask:0xf
  s_nop 1
  v_add_f32_dpp v72, v72, v72 row_ror:2 row_mask:0xf bank_mask:0xf
  s_nop 1
  v_add_f32_dpp v72, v72, v72 row_ror:1 row_mask:0xf bank_mask:0xf
  v_mul_f32 v72, 0x3acccccd, v72
  v_sub_f32 v74, 0, v72
  v_mov_b32 v75, v74
  v_pk_add_f32 v[32:33], v[32:33], v[74:75]
  v_pk_add_f32 v[34:35], v[34:35], v[74:75]
  v_pk_add_f32 v[36:37], v[36:37], v[74:75]
  v_pk_add_f32 v[38:39], v[38:39], v[74:75]
  v_pk_add_f32 v[40:41], v[40:41], v[74:75]
  v_pk_add_f32 v[42:43], v[42:43], v[74:75]
  v_pk_add_f32 v[44:45], v[44:45], v[74:75]
  v_pk_add_f32 v[46:47], v[46:47], v[74:75]
  v_pk_add_f32 v[48:49], v[48:49], v[74:75]
  v_pk_add_f32 v[50:51], v[50:51], v[74:75]
  v_pk_add_f32 v[52:53], v[52:53], v[74:75]
  v_pk_add_f32 v[54:55], v[54:55], v[74:75]
  v_pk_add_f32 v[56:57], v[56:57], v[74:75]
  v_pk_add_f32 v[58:59], v[58:59], v[74:75]
  v_pk_add_f32 v[60:61], v[60:61], v[74:75]
  v_pk_add_f32 v[62:63], v[62:63], v[74:75]
  v_pk_add_f32 v[64:65], v[64:65], v[74:75]
  v_pk_add_f32 v[66:67], v[66:67], v[74:75]
  v_pk_add_f32 v[68:69], v[68:69], v[74:75]
  v_pk_add_f32 v[70:71], v[70:71], v[74:75]
  v_pk_mul_f32 v[76:77], v[32:33], v[32:33]
  v_pk_fma_f32 v[76:77], v[34:35], v[34:35], v[76:77]
  v_pk_fma_f32 v[76:77], v[36:37], v[36:37], v[76:77]
  v_pk_fma_f32 v[76:77], v[38:39], v[38:39], v[76:77]
  v_pk_fma_f32 v[76:77], v[40:41], v[40:41], v[76:77]
  v_pk_fma_f32 v[76:77], v[42:43], v[42:43], v[76:77]
  v_pk_fma_f32 v[76:77], v[44:45], v[44:45], v[76:77]
  v_pk_fma_f32 v[76:77], v[46:47], v[46:47], v[76:77]
  v_pk_fma_f32 v[76:77], v[48:49], v[48:49], v[76:77]
  v_pk_fma_f32 v[76:77], v[50:51], v[50:51], v[76:77]
  v_pk_fma_f32 v[76:77], v[52:53], v[52:53], v[76:77]
  v_pk_fma_f32 v[76:77], v[54:55], v[54:55], v[76:77]
  v_pk_fma_f32 v[76:77], v[56:57], v[56:57], v[76:77]
  v_pk_fma_f32 v[76:77], v[58:59], v[58:59], v[76:77]
  v_pk_fma_f32 v[76:77], v[60:61], v[60:61], v[76:77]
  v_pk_fma_f32 v[76:77], v[62:63], v[62:63], v[76:77]
  v_pk_fma_f32 v[76:77], v[64:65], v[64:65], v[76:77]
  v_pk_fma_f32 v[76:77], v[66:67], v[66:67], v[76:77]
  v_pk_fma_f32 v[76:77], v[68:69], v[68:69], v[76:77]
  v_pk_fma_f32 v[76:77], v[70:71], v[70:71], v[76:77]
  v_add_f32 v76, v76, v77
  s_nop 1
  v_add_f32_dpp v76, v76, v76 row_ror:8 row_mask:0xf bank_mask:0xf
  s_nop 1
  v_add_f32_dpp v76, v76, v76 row_ror:4 row_mask:0xf bank_mask:0xf
  s_nop 1
  v_add_f32_dpp v76, v76, v76 row_ror:2 row_mask:0xf bank_mask:0xf
  s_nop 1
  v_add_f32_dpp v76, v76, v76 row_ror:1 row_mask:0xf bank_mask:0xf
  v_mov_b32 v77, 0x3727c5ac
  v_fmac_f32 v77, 0x3acccccd, v76
  v_rsq_f32 v77, v77
  s_nop 0
  v_mul_f32 v78, v74, v77
  v_lshlrev_b32 v5, 2, v3
  v_cmp_eq_u32 vcc, 0, v4
  s_nop 0
  s_and_saveexec_b64 s[44:45], vcc
  s_movk_i32 s46, 8192
  buffer_store_dword v77, v5, s[24:27], 0 offen sc1
  buffer_store_dword v78, v5, s[24:27], s46 offen sc1
  s_mov_b64 exec, s[44:45]
  s_branch KA_JOIN
KA_NONE:
  s_add_u32 s61, s100, 2240
  s_sub_u32 s63, s100, 448
  s_mul_hi_u32 s54, s63, 0x1999999a
  s_mul_i32 s55, s54, 10
  s_sub_u32 s55, s63, s55
  s_mov_b32 s56, s50
  s_and_b32 s57, s51, 0xffff
  s_mov_b32 s58, 1966080
  s_mov_b32 s59, 0x20000
  s_mul_i32 s60, s55, 196608
  s_mul_i32 s10, s54, 192
  s_add_u32 s60, s60, s10
  s_cmp_ge_u32 s63, 160
  s_cselect_b32 s60, 0x10000000, s60
  v_add_u32 v100, 0, v0
  s_mov_b32 s63, 0x15555556
  v_mul_hi_u32 v101, v100, s63
  v_mul_u32_u24 v102, 12, v101
  v_sub_u32 v102, v100, v102
  v_mul_u32_u24 v103, 3072, v101
  v_lshl_add_u32 v103, v102, 4, v103
  buffer_load_dwordx4 v[144:147], v103, s[56:59], s60 offen
  v_add_u32 v100, 256, v0
  s_mov_b32 s63, 0x15555556
  v_mul_hi_u32 v101, v100, s63
  v_mul_u32_u24 v102, 12, v101
  v_sub_u32 v102, v100, v102
  v_mul_u32_u24 v103, 3072, v101
  v_lshl_add_u32 v103, v102, 4, v103
  buffer_load_dwordx4 v[148:151], v103, s[56:59], s60 offen
  v_add_u32 v100, 512, v0
  s_mov_b32 s63, 0x15555556
  v_mul_hi_u32 v101, v100, s63
  v_mul_u32_u24 v102, 12, v101
  v_sub_u32 v102, v100, v102
  v_mul_u32_u24 v103, 3072, v101
  v_lshl_add_u32 v103, v102, 4, v103
  buffer_load_dwordx4 v[152:155], v103, s[56:59], s60 offen
  s_cmp_ge_u32 s100, 608
  s_cbranch_scc0 KA_NOCPF
  s_getpc_b64 s[46:47]
KA_PC:
  s_sub_u32 s46, s46, KA_PC-ka_kernel
  s_subb_u32 s47, s47, 0
  s_sub_u32 s63, s100, 608
  s_lshl_b32 s63, s63, 11
  v_lshlrev_b32 v104, 3, v0
  v_add_u32 v104, s63, v104
  v_cmp_gt_u32 vcc, CODE_LEN, v104
  s_nop 0
  s_and_saveexec_b64 s[44:45], vcc
  s_cbranch_execz KA_CPF0
  v_mov_b32 v103, s47
  v_add_co_u32 v102, vcc, s46, v104
  s_nop 1
  v_addc_co_u32 v103, vcc, 0, v103, vcc
  global_load_dwordx2 v[144:145], v[102:103], off
KA_CPF0:
  s_mov_b64 exec, s[44:45]
KA_NOCPF:
  s_waitcnt vmcnt(0)
KA_JOIN:
  v_and_b32 v3, 15, v1
  v_lshrrev_b32 v48, 4, v1
  v_lshlrev_b32 v50, 5, v3
  v_lshl_add_u32 v50, v48, 3, v50
  v_add_u32 v21, s38, v50
  v_mov_b32 v22, v21
  v_lshlrev_b32 v23, 1, v50
  s_lshl_b32 s39, s33, 11
  v_add_u32 v23, s39, v23
  v_lshlrev_b32 v16, 4, v1
  v_add_u32 v16, s37, v16
  v_add_u32 v16, 32, v16
  v_bfe_u32 v54, v1, 2, 2
  v_sub_u32 v55, 4, v54
  v_and_b32 v55, 3, v55
  v_mul_u32_u24 v55, 4160, v55
  v_min_u32 v56, 1, v54
  v_lshlrev_b32 v56, 3, v56
  v_sub_u32 v55, v55, v56
  v_lshlrev_b32 v56, 4, v48
  v_sub_u32 v55, v55, v56
  v_and_b32 v56, 3, v1
  v_lshl_add_u32 v55, v56, 3, v55
  s_lshl_b32 s42, s33, 7
  s_add_u32 s43, s42, 56
  v_add_u32 v17, s43, v55
  v_lshlrev_b32 v56, 5, v3
  v_lshl_add_u32 v56, v48, 4, v56
  s_sub_u32 s43, 17024, s42
  v_add_u32 v18, s43, v56
  s_add_u32 s43, s37, 17120
  v_add_u32 v19, s43, v50
  v_lshlrev_b32 v20, 4, v1
  v_mov_b32 v60, 0
  v_mov_b32 v61, 0
  v_mov_b32 v62, 0
  v_mov_b32 v63, 0
  s_cmp_eq_u32 s33, 1
  s_cbranch_scc0 KA_NOZ
  v_cmp_gt_u32 vcc, 30, v1
  s_nop 0
  s_and_saveexec_b64 s[44:45], vcc
  ds_write_b128 v20, v[60:63] offset:16640
  s_mov_b64 exec, s[44:45]
KA_NOZ:
  v_mov_b32_dpp v124, v120 row_shl:1 row_mask:0xf bank_mask:0xf
  v_mov_b32_dpp v125, v121 row_shl:1 row_mask:0xf bank_mask:0xf
  ds_write_b128 v16, v[120:123]
  v_alignbit_b32 v64, v121, v120, 16
  v_alignbit_b32 v65, v122, v121, 16
  v_alignbit_b32 v66, v123, v122, 16
  v_alignbit_b32 v67, v124, v123, 16
  v_mov_b32 v12, v121
  v_mov_b32 v13, v122
  v_mov_b32 v14, v123
  v_mov_b32 v15, v124
  ds_write_b128 v16, v[64:67] offset:4160
  v_alignbit_b32 v68, v122, v121, 16
  v_alignbit_b32 v69, v123, v122, 16
  v_alignbit_b32 v70, v124, v123, 16
  v_alignbit_b32 v71, v125, v124, 16
  ds_write_b128 v16, v[12:15] offset:8320
  ds_write_b128 v16, v[68:71] offset:12480
  s_cmp_eq_u32 s33, 0
  s_cbranch_scc0 KA_NOP
  v_readfirstlane_b32 s46, v120
  v_readfirstlane_b32 s47, v121
  s_nop 1
  s_lshl_b32 s48, s46, 16
  s_lshr_b32 s49, s46, 16
  s_lshl_b32 s10, s47, 16
  s_or_b32 s49, s49, s10
  v_cmp_eq_u32 vcc, 3, v1
  v_mov_b32 v72, s48
  s_nop 0
  v_cndmask_b32 v62, 0, v72, vcc
  v_mov_b32 v73, s49
  v_cndmask_b32 v63, 0, v73, vcc
  v_cmp_eq_u32 vcc, 2, v1
  v_mov_b32 v73, s46
  s_nop 0
  v_cndmask_b32 v63, v63, v73, vcc
  v_cmp_eq_u32 vcc, 1, v1
  s_nop 1
  v_cndmask_b32 v63, v63, v72, vcc
  v_mul_u32_u24 v74, 4160, v1
  v_mov_b32 v76, 0
  v_mov_b32 v77, 0
  v_mov_b32 v78, 0
  v_mov_b32 v79, 0
  v_cmp_gt_u32 vcc, 4, v1
  s_nop 0
  s_and_saveexec_b64 s[44:45], vcc
  ds_write_b128 v74, v[76:79]
  ds_write_b128 v74, v[60:63] offset:16
  s_mov_b64 exec, s[44:45]
KA_NOP:
  s_waitcnt lgkmcnt(0)
  s_mul_i32 s32, s11, 2654435761
  s_add_u32 s32, s32, 2135587861
  s_lshl_b32 s11, s61, 2
  s_lshl_b32 s35, s34, 16
  s_and_b32 s34, s34, 0xffff0000
  s_bitcmp1_b32 s2, 0
  s_cselect_b32 s34, s34, s35
  s_mov_b32 s35, s34
  s_cmp_lt_u32 s100, 320
  s_cbranch_scc1 KA_UDONE
  s_cmp_ge_u32 s100, 608
  s_cbranch_scc1 KA_UDONE
  s_cmp_lt_u32 s100, 448
  s_cbranch_scc1 KA_U2
  v_lshlrev_b32 v104, 4, v0
  v_add_u32 v104, 21248, v104
  v_lshrrev_b32 v100, 4, v1
  v_bfe_u32 v101, v1, 2, 2
  v_and_b32 v102, 3, v1
  v_lshl_add_u32 v101, v100, 2, v101
  ds_write_b128 v104, v[144:147] offset:0
  ds_write_b128 v104, v[148:151] offset:4096
  ds_write_b128 v104, v[152:155] offset:8192
  s_waitcnt lgkmcnt(0)
  s_barrier
  s_cmp_eq_u32 s33, 3
  s_cbranch_scc1 KA_UDONE
  v_mul_u32_u24 v101, 192, v101
  v_lshl_add_u32 v101, v102, 3, v101
  s_lshl_b32 s60, s33, 6
  s_add_u32 s60, s60, 21248
  v_add_u32 v101, s60, v101
  ds_read_b64_tr_b16 v[144:145], v101 offset:0
  ds_read_b64_tr_b16 v[146:147], v101 offset:3072
  ds_read_b64_tr_b16 v[148:149], v101 offset:32
  ds_read_b64_tr_b16 v[150:151], v101 offset:3104
  ds_read_b64_tr_b16 v[152:153], v101 offset:6144
  ds_read_b64_tr_b16 v[154:155], v101 offset:9216
  ds_read_b64_tr_b16 v[156:157], v101 offset:6176
  ds_read_b64_tr_b16 v[158:159], v101 offset:9248
  v_mov_b32 v12, 0x3f803f80
  v_mov_b32 v13, 0x3f803f80
  v_mov_b32 v14, 0x3f803f80
  v_mov_b32 v15, 0x3f803f80
  s_waitcnt lgkmcnt(0)
  s_nop 0
  v_mfma_f32_16x16x32_bf16 v[96:99], v[144:147], v[12:15], 0
  v_mfma_f32_16x16x32_bf16 v[108:111], v[148:151], v[12:15], 0
  v_mfma_f32_16x16x32_bf16 v[96:99], v[152:155], v[12:15], v[96:99]
  v_mfma_f32_16x16x32_bf16 v[108:111], v[156:159], v[12:15], v[108:111]
  s_add_u32 s56, s8, 7929856
  s_addc_u32 s57, s9, 0
  s_and_b32 s57, s57, 0xffff
  s_mov_b32 s58, 61440
  s_mov_b32 s59, 0x20000
  s_mul_i32 s60, s55, 6144
  s_mul_i32 s61, s54, 384
  s_add_u32 s60, s60, s61
  s_lshl_b32 s61, s33, 7
  s_add_u32 s60, s60, s61
  v_lshlrev_b32 v100, 4, v100
  v_and_b32 v102, 15, v1
  v_cmp_eq_u32 vcc, 0, v102
  s_nop 0
  s_and_saveexec_b64 s[44:45], vcc
  buffer_store_dwordx4 v[96:99], v100, s[56:59], s60 offen sc1
  buffer_store_dwordx4 v[108:111], v100, s[56:59], s60 offen offset:64 sc1
  s_mov_b64 exec, s[44:45]
  s_branch KA_UDONE
KA_U2:
  v_lshlrev_b32 v104, 4, v0
  v_add_u32 v104, 21248, v104
  v_lshrrev_b32 v100, 4, v1
  v_bfe_u32 v101, v1, 2, 2
  v_and_b32 v102, 3, v1
  v_lshl_add_u32 v101, v100, 2, v101
  ds_write_b128 v104, v[144:147] offset:0
  ds_write_b128 v104, v[148:151] offset:4096
  ds_write_b128 v104, v[152:155] offset:8192
  ds_write_b128 v104, v[156:159] offset:12288
  s_waitcnt lgkmcnt(0)
  s_barrier
  v_mul_u32_u24 v101, 160, v101
  v_lshl_add_u32 v101, v102, 3, v101
  v_add_u32 v101, 21248, v101
  s_cmp_eq_u32 s33, 0
  s_cbranch_scc0 KA_UW1
  ds_read_b64_tr_b16 v[144:145], v101 offset:0
  ds_read_b64_tr_b16 v[146:147], v101 offset:2560
  ds_read_b64_tr_b16 v[148:149], v101 offset:128
  ds_read_b64_tr_b16 v[150:151], v101 offset:2688
  ds_read_b64_tr_b16 v[152:153], v101 offset:5216
  ds_read_b64_tr_b16 v[154:155], v101 offset:7776
  ds_read_b64_tr_b16 v[156:157], v101 offset:10304
  ds_read_b64_tr_b16 v[158:159], v101 offset:12864
  s_waitcnt lgkmcnt(0)
  s_branch KA_UDONE
KA_UW1:
  s_cmp_eq_u32 s33, 1
  s_cbranch_scc0 KA_UW2
  ds_read_b64_tr_b16 v[144:145], v101 offset:32
  ds_read_b64_tr_b16 v[146:147], v101 offset:2592
  ds_read_b64_tr_b16 v[148:149], v101 offset:5120
  ds_read_b64_tr_b16 v[150:151], v101 offset:7680
  ds_read_b64_tr_b16 v[152:153], v101 offset:5248
  ds_read_b64_tr_b16 v[154:155], v101 offset:7808
  ds_read_b64_tr_b16 v[156:157], v101 offset:10336
  ds_read_b64_tr_b16 v[158:159], v101 offset:12896
  s_waitcnt lgkmcnt(0)
  s_branch KA_UDONE
KA_UW2:
  s_cmp_eq_u32 s33, 2
  s_cbranch_scc0 KA_UW3
  ds_read_b64_tr_b16 v[144:145], v101 offset:64
  ds_read_b64_tr_b16 v[146:147], v101 offset:2624
  ds_read_b64_tr_b16 v[148:149], v101 offset:5152
  ds_read_b64_tr_b16 v[150:151], v101 offset:7712
  ds_read_b64_tr_b16 v[152:153], v101 offset:10240
  ds_read_b64_tr_b16 v[154:155], v101 offset:12800
  ds_read_b64_tr_b16 v[156:157], v101 offset:10368
  ds_read_b64_tr_b16 v[158:159], v101 offset:12928
  s_waitcnt lgkmcnt(0)
  s_branch KA_UDONE
KA_UW3:
  ds_read_b64_tr_b16 v[144:145], v101 offset:96
  ds_read_b64_tr_b16 v[146:147], v101 offset:2656
  ds_read_b64_tr_b16 v[148:149], v101 offset:5184
  ds_read_b64_tr_b16 v[150:151], v101 offset:7744
  ds_read_b64_tr_b16 v[152:153], v101 offset:10272
  ds_read_b64_tr_b16 v[154:155], v101 offset:12832
  s_waitcnt lgkmcnt(0)
KA_UDONE:
  s_setprio 0
  s_cmp_lt_u32 s100, 320
  s_cbranch_scc0 KA_DRAIN0
  s_waitcnt vmcnt(2)
  s_branch KA_DRAIN1
KA_DRAIN0:
  s_waitcnt vmcnt(0)
KA_DRAIN1:
  s_barrier
  s_cmp_eq_u32 s33, 0
  s_cbranch_scc0 KA_NOFLAG
  v_lshlrev_b32 v4, 7, v1
  v_add_u32 v4, s11, v4
  v_mov_b32 v5, s32
  s_cmp_lt_u32 s100, 320
  s_cselect_b32 s60, 255, 1
  s_mov_b32 exec_lo, s60
  s_mov_b32 exec_hi, 0
  buffer_store_dword v5, v4, s[96:99], 0 offen sc1
  s_mov_b64 exec, -1
  s_waitcnt vmcnt(1)
  s_branch KA_FLAGD
KA_NOFLAG:
  s_waitcnt vmcnt(0)
KA_FLAGD:
  s_cmp_lt_u32 s100, 320
  s_cbranch_scc0 KA_NOX
  s_mov_b32 s45, 0x05040100
  s_mov_b32 s46, 0x07060302
  s_mov_b32 s43, 0x20000
  s_barrier
  ds_read_b32 v29, v38 offset:0
  ds_read_b32 v30, v38 offset:128
  ds_read_b32 v31, v38 offset:256
  ds_read_b32 v32, v38 offset:384
  ds_read_b32 v33, v38 offset:512
  ds_read_b32 v34, v38 offset:640
  ds_read_b32 v35, v38 offset:768
  ds_read_b32 v36, v38 offset:896
  s_waitcnt lgkmcnt(0)
  v_perm_b32 v108, v30, v29, s45
  v_perm_b32 v112, v30, v29, s46
  v_perm_b32 v109, v32, v31, s45
  v_perm_b32 v113, v32, v31, s46
  v_perm_b32 v110, v34, v33, s45
  v_perm_b32 v114, v34, v33, s46
  v_perm_b32 v111, v36, v35, s45
  v_perm_b32 v115, v36, v35, s46
  ds_write_b128 v37, v[108:111] offset:8192
  ds_write_b128 v37, v[112:115] offset:8320
  s_waitcnt lgkmcnt(0)
  s_barrier
  ds_read_b128 v[88:91], v116 offset:8192
  ds_read_b128 v[92:95], v116 offset:12288
  s_waitcnt lgkmcnt(0)
  buffer_store_dwordx4 v[88:91], v117, s[20:23], 0 offen sc1
  buffer_store_dwordx4 v[92:95], v117, s[20:23], s43 offen sc1
  s_waitcnt vmcnt(0)
  s_barrier
  s_cmp_eq_u32 s33, 0
  s_cbranch_scc0 KA_NOX
  s_mul_hi_u32 s60, s100, 0x1999999a
  s_mul_i32 s63, s60, 10
  s_sub_u32 s63, s100, s63
  s_lshl_b32 s63, s63, 5
  s_add_u32 s60, s60, s63
  s_lshl_b32 s60, s60, 2
  s_add_u32 s60, s60, 11520
  v_mov_b32 v4, s60
  v_mov_b32 v5, s32
  s_mov_b64 exec, 1
  buffer_store_dword v5, v4, s[96:99], 0 offen sc1
  s_mov_b64 exec, -1
KA_NOX:
  s_cmp_eq_u32 s33, 0
  s_cbranch_scc0 KA_NOPOLL
  s_mov_b32 exec_lo, -1
  s_mov_b32 exec_hi, 0
  s_getreg_b32 s63, hwreg(HW_REG_XCC_ID, 0, 3)
  s_lshr_b32 s60, s2, 6
  s_mul_i32 s60, s60, 8
  s_add_u32 s60, s60, s63
  s_lshl_b32 s60, s60, 7
  v_lshlrev_b32 v4, 2, v1
  v_add_u32 v4, s60, v4
  s_mov_b32 s60, 0
KA_POLL:
  buffer_load_dword v6, v4, s[96:99], 0 offen sc1
  s_waitcnt vmcnt(0)
  v_cmp_ne_u32 vcc, s32, v6
  s_add_u32 s60, s60, 1
  s_cmp_ge_u32 s60, 200000
  s_cbranch_scc1 KA_POLLX
  s_cbranch_vccz KA_POLLX
  s_sleep 16
  s_branch KA_POLL
KA_POLLX:
  s_mov_b64 exec, -1
KA_NOPOLL:
  s_barrier
  buffer_load_dwordx4 v[24:27], v119, s[16:19], 0 offen sc1
  v_lshlrev_b32 v4, 3, v1
  s_mov_b32 s63, 10240
  v_and_b32 v5, 31, v1
  v_lshlrev_b32 v5, 2, v5
  s_lshr_b32 s60, s2, 6
  s_lshl_b32 s60, s60, 7
  s_add_u32 s60, s60, 11520
  v_add_u32 v5, s60, v5
  s_movk_i32 s41, 8192
  s_waitcnt vmcnt(0)
  ds_write_b128 v16, v[24:27] offset:17088
  s_mov_b32 s46, 268435456
  s_mov_b32 s47, 268435456
  s_mov_b32 s48, 268435456
  s_mov_b32 s49, 268435456
  s_add_u32 s56, s8, 16777216
  s_addc_u32 s57, s9, 0
  s_and_b32 s57, s57, 0xffff
  s_mov_b32 s58, 1966080
  s_mov_b32 s59, 0x20000
  s_cmp_lt_u32 s100, 320
  s_cbranch_scc1 KA_SDONE
  s_cmp_ge_u32 s100, 608
  s_cbranch_scc1 KA_SDONE
  s_cmp_lt_u32 s100, 448
  s_cbranch_scc1 KA_S2
  s_cmp_eq_u32 s33, 3
  s_cbranch_scc1 KA_SDONE
  s_add_u32 s56, s8, 14680064
  s_addc_u32 s57, s9, 0
  s_and_b32 s57, s57, 0xffff
  s_mov_b32 s58, 1966080
  s_mov_b32 s59, 0x20000
  s_mul_i32 s60, s54, 120
  s_mul_i32 s61, s55, 12
  s_add_u32 s60, s60, s61
  s_lshl_b32 s61, s33, 1
  s_add_u32 s60, s60, s61
  s_lshl_b32 s60, s60, 10
  s_add_u32 s46, s60, 0
  s_add_u32 s47, s60, 1024
  s_add_u32 s48, s60, 6144
  s_add_u32 s49, s60, 7168
  s_branch KA_SDONE
KA_S2:
  s_mul_i32 s60, s54, 48
  s_mul_i32 s61, s55, 3
  s_add_u32 s60, s60, s61
  s_mul_i32 s60, s60, 5
  s_add_u32 s60, s60, s33
  s_lshl_b32 s60, s60, 10
  s_add_u32 s46, s60, 0
  s_add_u32 s47, s60, 4096
  s_add_u32 s48, s60, 8192
  s_cmp_eq_u32 s33, 3
  s_cbranch_scc1 KA_SDONE
  s_add_u32 s49, s60, 12288
KA_SDONE:
  s_waitcnt lgkmcnt(0)
  s_barrier
  ds_read_b64_tr_b16 v[48:49], v17 offset:8
  ds_read_b64_tr_b16 v[50:51], v17 offset:0
  ds_read_b128 v[80:83], v18 offset:64
  ds_read_b128 v[84:87], v18 offset:576
  ds_read_b128 v[88:91], v18 offset:1088
  ds_read_b128 v[92:95], v18 offset:1600
  ds_read_b128 v[96:99], v18 offset:2112
  ds_read_b128 v[100:103], v18 offset:2624
  ds_read_b128 v[104:107], v18 offset:3136
  ds_read_b128 v[108:111], v18 offset:3648
  ds_read_b64_tr_b16 v[52:53], v17 offset:520
  ds_read_b64_tr_b16 v[54:55], v17 offset:512
  ds_read_b64_tr_b16 v[56:57], v17 offset:1032
  ds_read_b64_tr_b16 v[58:59], v17 offset:1024
  ds_read_b64_tr_b16 v[60:61], v17 offset:1544
  ds_read_b64_tr_b16 v[62:63], v17 offset:1536
  ds_read_b64_tr_b16 v[64:65], v17 offset:2056
  ds_read_b64_tr_b16 v[66:67], v17 offset:2048
  ds_read_b64_tr_b16 v[68:69], v17 offset:2568
  ds_read_b64_tr_b16 v[70:71], v17 offset:2560
  ds_read_b64_tr_b16 v[72:73], v17 offset:3080
  ds_read_b64_tr_b16 v[74:75], v17 offset:3072
  ds_read_b64_tr_b16 v[76:77], v17 offset:3592
  ds_read_b64_tr_b16 v[78:79], v17 offset:3584
  s_waitcnt lgkmcnt(15)
  v_mfma_f32_16x16x32_bf16 v[112:115], v[48:51], v[80:83], 0
  v_mfma_f32_16x16x32_bf16 v[116:119], v[48:51], v[84:87], 0
  v_mfma_f32_16x16x32_bf16 v[120:123], v[48:51], v[88:91], 0
  v_mfma_f32_16x16x32_bf16 v[124:127], v[48:51], v[92:95], 0
  v_mfma_f32_16x16x32_bf16 v[128:131], v[48:51], v[96:99], 0
  v_mfma_f32_16x16x32_bf16 v[132:135], v[48:51], v[100:103], 0
  v_mfma_f32_16x16x32_bf16 v[136:139], v[48:51], v[104:107], 0
  s_waitcnt lgkmcnt(14)
  v_mfma_f32_16x16x32_bf16 v[140:143], v[48:51], v[108:111], 0
  ds_read_b64_tr_b16 v[48:49], v17 offset:72
  ds_read_b64_tr_b16 v[50:51], v17 offset:64
  ds_read_b128 v[108:111], v18 offset:3584
  buffer_load_dwordx2 v[6:7], v4, s[96:99], s63 offen
  s_waitcnt lgkmcnt(15)
  v_mfma_f32_16x16x32_bf16 v[116:119], v[52:55], v[80:83], v[116:119]
  v_mfma_f32_16x16x32_bf16 v[120:123], v[52:55], v[84:87], v[120:123]
  v_mfma_f32_16x16x32_bf16 v[124:127], v[52:55], v[88:91], v[124:127]
  v_mfma_f32_16x16x32_bf16 v[128:131], v[52:55], v[92:95], v[128:131]
  v_mfma_f32_16x16x32_bf16 v[132:135], v[52:55], v[96:99], v[132:135]
  v_mfma_f32_16x16x32_bf16 v[136:139], v[52:55], v[100:103], v[136:139]
  v_mfma_f32_16x16x32_bf16 v[140:143], v[52:55], v[104:107], v[140:143]
  ds_read_b64_tr_b16 v[52:53], v17 offset:584
  ds_read_b64_tr_b16 v[54:55], v17 offset:576
  ds_read_b128 v[104:107], v18 offset:3072
  buffer_load_dword v8, v5, s[96:99], 0 offen
  s_waitcnt lgkmcnt(15)
  v_mfma_f32_16x16x32_bf16 v[120:123], v[56:59], v[80:83], v[120:123]
  v_mfma_f32_16x16x32_bf16 v[124:127], v[56:59], v[84:87], v[124:127]
  v_mfma_f32_16x16x32_bf16 v[128:131], v[56:59], v[88:91], v[128:131]
  v_mfma_f32_16x16x32_bf16 v[132:135], v[56:59], v[92:95], v[132:135]
  v_mfma_f32_16x16x32_bf16 v[136:139], v[56:59], v[96:99], v[136:139]
  v_mfma_f32_16x16x32_bf16 v[140:143], v[56:59], v[100:103], v[140:143]
  ds_read_b64_tr_b16 v[56:57], v17 offset:1096
  ds_read_b64_tr_b16 v[58:59], v17 offset:1088
  ds_read_b128 v[100:103], v18 offset:2560
  s_waitcnt lgkmcnt(15)
  v_mfma_f32_16x16x32_bf16 v[124:127], v[60:63], v[80:83], v[124:127]
  v_mfma_f32_16x16x32_bf16 v[128:131], v[60:63], v[84:87], v[128:131]
  v_mfma_f32_16x16x32_bf16 v[132:135], v[60:63], v[88:91], v[132:135]
  v_mfma_f32_16x16x32_bf16 v[136:139], v[60:63], v[92:95], v[136:139]
  v_mfma_f32_16x16x32_bf16 v[140:143], v[60:63], v[96:99], v[140:143]
  ds_read_b64_tr_b16 v[60:61], v17 offset:1608
  ds_read_b64_tr_b16 v[62:63], v17 offset:1600
  ds_read_b128 v[96:99], v18 offset:2048
  v_mfma_f32_16x16x32_bf16 v[128:131], v[64:67], v[80:83], v[128:131]
  v_mfma_f32_16x16x32_bf16 v[132:135], v[64:67], v[84:87], v[132:135]
  v_mfma_f32_16x16x32_bf16 v[136:139], v[64:67], v[88:91], v[136:139]
  v_mfma_f32_16x16x32_bf16 v[140:143], v[64:67], v[92:95], v[140:143]
  ds_read_b64_tr_b16 v[64:65], v17 offset:2120
  ds_read_b64_tr_b16 v[66:67], v17 offset:2112
  ds_read_b128 v[92:95], v18 offset:1536
  s_waitcnt lgkmcnt(15)
  v_mfma_f32_16x16x32_bf16 v[132:135], v[68:71], v[80:83], v[132:135]
  v_mfma_f32_16x16x32_bf16 v[136:139], v[68:71], v[84:87], v[136:139]
  v_mfma_f32_16x16x32_bf16 v[140:143], v[68:71], v[88:91], v[140:143]
  ds_read_b64_tr_b16 v[68:69], v17 offset:2632
  ds_read_b64_tr_b16 v[70:71], v17 offset:2624
  ds_read_b128 v[88:91], v18 offset:1024
  v_mfma_f32_16x16x32_bf16 v[136:139], v[72:75], v[80:83], v[136:139]
  v_mfma_f32_16x16x32_bf16 v[140:143], v[72:75], v[84:87], v[140:143]
  ds_read_b64_tr_b16 v[72:73], v17 offset:3144
  ds_read_b64_tr_b16 v[74:75], v17 offset:3136
  ds_read_b128 v[84:87], v18 offset:512
  v_mfma_f32_16x16x32_bf16 v[140:143], v[76:79], v[80:83], v[140:143]
  ds_read_b64_tr_b16 v[76:77], v17 offset:3656
  ds_read_b64_tr_b16 v[78:79], v17 offset:3648
  ds_read_b128 v[80:83], v18 offset:0
  s_waitcnt vmcnt(0)
  v_cmp_ne_u32 vcc, s32, v6
  v_cmp_ne_u32 s[44:45], s32, v7
  s_nop 0
  s_or_b64 vcc, vcc, s[44:45]
  v_cmp_ne_u32 s[44:45], s32, v8
  s_nop 0
  s_or_b64 vcc, vcc, s[44:45]
  s_cbranch_vccz KA_STOK
  s_mov_b32 s60, 0
KA_STPOLL:
  buffer_load_dwordx2 v[6:7], v4, s[96:99], s63 offen sc1
  buffer_load_dword v8, v5, s[96:99], 0 offen sc1
  s_waitcnt vmcnt(0)
  v_cmp_ne_u32 vcc, s32, v6
  v_cmp_ne_u32 s[44:45], s32, v7
  s_nop 0
  s_or_b64 vcc, vcc, s[44:45]
  v_cmp_ne_u32 s[44:45], s32, v8
  s_nop 0
  s_or_b64 vcc, vcc, s[44:45]
  s_add_u32 s60, s60, 1
  s_cmp_ge_u32 s60, 200000
  s_cbranch_scc1 KA_STOK
  s_cbranch_vccz KA_STOK
  s_sleep 4
  s_branch KA_STPOLL
KA_STOK:
  s_waitcnt lgkmcnt(15)
  v_mfma_f32_16x16x32_bf16 v[140:143], v[48:51], v[108:111], v[140:143]
  buffer_load_dwordx2 v[28:29], v22, s[20:23], 0 offen sc1
  buffer_load_dwordx2 v[30:31], v22, s[20:23], 0 offen offset:512 sc1
  v_mfma_f32_16x16x32_bf16 v[136:139], v[48:51], v[104:107], v[136:139]
  v_mfma_f32_16x16x32_bf16 v[140:143], v[52:55], v[104:107], v[140:143]
  buffer_load_dwordx4 v[32:35], v23, s[24:27], 0 offen sc1
  buffer_load_dwordx4 v[36:39], v23, s[24:27], 0 offen offset:1024 sc1
  v_mfma_f32_16x16x32_bf16 v[132:135], v[48:51], v[100:103], v[132:135]
  v_mfma_f32_16x16x32_bf16 v[136:139], v[52:55], v[100:103], v[136:139]
  v_mfma_f32_16x16x32_bf16 v[140:143], v[56:59], v[100:103], v[140:143]
  buffer_load_dwordx4 v[40:43], v23, s[24:27], s41 offen sc1
  s_waitcnt lgkmcnt(13)
  s_waitcnt lgkmcnt(12)
  v_mfma_f32_16x16x32_bf16 v[128:131], v[48:51], v[96:99], v[128:131]
  v_mfma_f32_16x16x32_bf16 v[132:135], v[52:55], v[96:99], v[132:135]
  v_mfma_f32_16x16x32_bf16 v[136:139], v[56:59], v[96:99], v[136:139]
  v_mfma_f32_16x16x32_bf16 v[140:143], v[60:63], v[96:99], v[140:143]
  buffer_load_dwordx4 v[44:47], v23, s[24:27], s41 offen offset:1024 sc1
  s_waitcnt lgkmcnt(10)
  s_waitcnt lgkmcnt(9)
  v_mfma_f32_16x16x32_bf16 v[124:127], v[48:51], v[92:95], v[124:127]
  v_mfma_f32_16x16x32_bf16 v[128:131], v[52:55], v[92:95], v[128:131]
  v_mfma_f32_16x16x32_bf16 v[132:135], v[56:59], v[92:95], v[132:135]
  v_mfma_f32_16x16x32_bf16 v[136:139], v[60:63], v[92:95], v[136:139]
  v_mfma_f32_16x16x32_bf16 v[140:143], v[64:67], v[92:95], v[140:143]
  buffer_store_dwordx4 v[144:147], v20, s[56:59], s46 offen sc1
  s_waitcnt lgkmcnt(7)
  s_waitcnt lgkmcnt(6)
  v_mfma_f32_16x16x32_bf16 v[120:123], v[48:51], v[88:91], v[120:123]
  v_mfma_f32_16x16x32_bf16 v[124:127], v[52:55], v[88:91], v[124:127]
  v_mfma_f32_16x16x32_bf16 v[128:131], v[56:59], v[88:91], v[128:131]
  v_mfma_f32_16x16x32_bf16 v[132:135], v[60:63], v[88:91], v[132:135]
  v_mfma_f32_16x16x32_bf16 v[136:139], v[64:67], v[88:91], v[136:139]
  v_mfma_f32_16x16x32_bf16 v[140:143], v[68:71], v[88:91], v[140:143]
  buffer_store_dwordx4 v[148:151], v20, s[56:59], s47 offen sc1
  s_waitcnt lgkmcnt(4)
  s_waitcnt lgkmcnt(3)
  v_mfma_f32_16x16x32_bf16 v[116:119], v[48:51], v[84:87], v[116:119]
  v_mfma_f32_16x16x32_bf16 v[120:123], v[52:55], v[84:87], v[120:123]
  v_mfma_f32_16x16x32_bf16 v[124:127], v[56:59], v[84:87], v[124:127]
  v_mfma_f32_16x16x32_bf16 v[128:131], v[60:63], v[84:87], v[128:131]
  v_mfma_f32_16x16x32_bf16 v[132:135], v[64:67], v[84:87], v[132:135]
  v_mfma_f32_16x16x32_bf16 v[136:139], v[68:71], v[84:87], v[136:139]
  v_mfma_f32_16x16x32_bf16 v[140:143], v[72:75], v[84:87], v[140:143]
  buffer_store_dwordx4 v[152:155], v20, s[56:59], s48 offen sc1
  s_waitcnt lgkmcnt(1)
  s_waitcnt lgkmcnt(0)
  v_mfma_f32_16x16x32_bf16 v[112:115], v[48:51], v[80:83], v[112:115]
  v_mfma_f32_16x16x32_bf16 v[116:119], v[52:55], v[80:83], v[116:119]
  v_mfma_f32_16x16x32_bf16 v[120:123], v[56:59], v[80:83], v[120:123]
  v_mfma_f32_16x16x32_bf16 v[124:127], v[60:63], v[80:83], v[124:127]
  v_mfma_f32_16x16x32_bf16 v[128:131], v[64:67], v[80:83], v[128:131]
  v_mfma_f32_16x16x32_bf16 v[132:135], v[68:71], v[80:83], v[132:135]
  v_mfma_f32_16x16x32_bf16 v[136:139], v[72:75], v[80:83], v[136:139]
  v_mfma_f32_16x16x32_bf16 v[140:143], v[76:79], v[80:83], v[140:143]
  buffer_store_dwordx4 v[156:159], v20, s[56:59], s49 offen sc1
  s_cmp_eq_u32 s33, 0
  s_cbranch_scc0 KA_W1
  ds_write_b128 v20, v[120:123] offset:29440
  ds_write_b128 v20, v[124:127] offset:32512
  ds_write_b128 v20, v[128:131] offset:34560
  ds_write_b128 v20, v[132:135] offset:37632
  ds_write_b128 v20, v[136:139] offset:39680
  ds_write_b128 v20, v[140:143] offset:42752
  s_waitcnt lgkmcnt(0)
  s_barrier
  ds_read_b128 v[48:51], v20 offset:21248
  ds_read_b128 v[52:55], v20 offset:22272
  ds_read_b128 v[56:59], v20 offset:23296
  ds_read_b64 v[60:61], v19 offset:0
  ds_read_b128 v[64:67], v20 offset:24320
  ds_read_b128 v[68:71], v20 offset:25344
  ds_read_b128 v[72:75], v20 offset:26368
  ds_read_b64 v[76:77], v19 offset:512
  s_waitcnt vmcnt(4) lgkmcnt(0)
  v_pk_add_f32 v[112:113], v[112:113], v[48:49]
  v_pk_add_f32 v[114:115], v[114:115], v[50:51]
  v_pk_add_f32 v[112:113], v[112:113], v[52:53]
  v_pk_add_f32 v[114:115], v[114:115], v[54:55]
  v_pk_add_f32 v[112:113], v[112:113], v[56:57]
  v_pk_add_f32 v[114:115], v[114:115], v[58:59]
  v_lshlrev_b32 v80, 16, v60
  v_and_b32 v81, 0xffff0000, v60
  v_lshlrev_b32 v82, 16, v61
  v_and_b32 v83, 0xffff0000, v61
  v_lshlrev_b32 v84, 16, v28
  v_and_b32 v85, 0xffff0000, v28
  v_lshlrev_b32 v86, 16, v29
  v_and_b32 v87, 0xffff0000, v29
  v_pk_fma_f32 v[112:113], v[80:81], s[34:35], v[112:113]
  v_pk_fma_f32 v[114:115], v[82:83], s[34:35], v[114:115]
  v_pk_fma_f32 v[88:89], v[84:85], v[32:33], v[40:41]
  v_pk_fma_f32 v[90:91], v[86:87], v[34:35], v[42:43]
  v_pk_fma_f32 v[88:89], v[88:89], v[112:113], v[84:85]
  v_pk_fma_f32 v[90:91], v[90:91], v[114:115], v[86:87]
  v_cvt_pk_bf16_f32 v92, v88, v89
  v_cvt_pk_bf16_f32 v93, v90, v91
  buffer_store_dwordx2 v[92:93], v21, s[28:31], 0 offen offset:0 sc1
  v_pk_add_f32 v[116:117], v[116:117], v[64:65]
  v_pk_add_f32 v[118:119], v[118:119], v[66:67]
  v_pk_add_f32 v[116:117], v[116:117], v[68:69]
  v_pk_add_f32 v[118:119], v[118:119], v[70:71]
  v_pk_add_f32 v[116:117], v[116:117], v[72:73]
  v_pk_add_f32 v[118:119], v[118:119], v[74:75]
  v_lshlrev_b32 v80, 16, v76
  v_and_b32 v81, 0xffff0000, v76
  v_lshlrev_b32 v82, 16, v77
  v_and_b32 v83, 0xffff0000, v77
  v_lshlrev_b32 v84, 16, v30
  v_and_b32 v85, 0xffff0000, v30
  v_lshlrev_b32 v86, 16, v31
  v_and_b32 v87, 0xffff0000, v31
  v_pk_fma_f32 v[116:117], v[80:81], s[34:35], v[116:117]
  v_pk_fma_f32 v[118:119], v[82:83], s[34:35], v[118:119]
  v_pk_fma_f32 v[88:89], v[84:85], v[36:37], v[44:45]
  v_pk_fma_f32 v[90:91], v[86:87], v[38:39], v[46:47]
  v_pk_fma_f32 v[88:89], v[88:89], v[116:117], v[84:85]
  v_pk_fma_f32 v[90:91], v[90:91], v[118:119], v[86:87]
  v_cvt_pk_bf16_f32 v94, v88, v89
  v_cvt_pk_bf16_f32 v95, v90, v91
  buffer_store_dwordx2 v[94:95], v21, s[28:31], 0 offen offset:512 sc1
  s_cmp_eq_u32 s2, 0
  s_cbranch_scc0 KA_NOSEED
  v_lshrrev_b32 v4, 5, v1
  v_mul_u32_u24 v4, 1024, v4
  v_and_b32 v5, 31, v1
  v_lshl_add_u32 v4, v5, 2, v4
  v_lshlrev_b32 v5, 2, v1
  s_mov_b32 s60, 0
KA_ALLPOLL:
  s_mov_b32 s63, 0
  buffer_load_dword v48, v4, s[96:99], s63 offen sc1
  s_mov_b32 s63, 2048
  buffer_load_dword v49, v4, s[96:99], s63 offen sc1
  s_mov_b32 s63, 4096
  buffer_load_dword v50, v4, s[96:99], s63 offen sc1
  s_mov_b32 s63, 6144
  buffer_load_dword v51, v4, s[96:99], s63 offen sc1
  s_mov_b32 s63, 8192
  buffer_load_dword v52, v4, s[96:99], s63 offen sc1
  s_mov_b32 s63, 10240
  buffer_load_dword v53, v5, s[96:99], s63 offen offset:0 sc1
  buffer_load_dword v54, v5, s[96:99], s63 offen offset:256 sc1
  buffer_load_dword v55, v5, s[96:99], s63 offen offset:512 sc1
  buffer_load_dword v56, v5, s[96:99], s63 offen offset:768 sc1
  buffer_load_dword v57, v5, s[96:99], s63 offen offset:1024 sc1
  s_waitcnt vmcnt(0)
  v_cmp_ne_u32 vcc, s32, v48
  v_cmp_ne_u32 s[44:45], s32, v49
  s_nop 0
  s_or_b64 vcc, vcc, s[44:45]
  v_cmp_ne_u32 s[44:45], s32, v50
  s_nop 0
  s_or_b64 vcc, vcc, s[44:45]
  v_cmp_ne_u32 s[44:45], s32, v51
  s_nop 0
  s_or_b64 vcc, vcc, s[44:45]
  v_cmp_ne_u32 s[44:45], s32, v52
  s_nop 0
  s_or_b64 vcc, vcc, s[44:45]
  v_cmp_ne_u32 s[44:45], s32, v53
  s_nop 0
  s_or_b64 vcc, vcc, s[44:45]
  v_cmp_ne_u32 s[44:45], s32, v54
  s_nop 0
  s_or_b64 vcc, vcc, s[44:45]
  v_cmp_ne_u32 s[44:45], s32, v55
  s_nop 0
  s_or_b64 vcc, vcc, s[44:45]
  v_cmp_ne_u32 s[44:45], s32, v56
  s_nop 0
  s_or_b64 vcc, vcc, s[44:45]
  v_cmp_ne_u32 s[44:45], s32, v57
  s_nop 0
  s_or_b64 vcc, vcc, s[44:45]
  s_add_u32 s60, s60, 1
  s_cmp_ge_u32 s60, 200000
  s_cbranch_scc1 KA_ALLX
  s_cbranch_vccz KA_ALLX
  s_sleep 16
  s_branch KA_ALLPOLL
KA_ALLX:
  s_add_u32 s56, s8, 8028160
  s_addc_u32 s57, s9, 0
  s_and_b32 s57, s57, 0xffff
  s_mov_b32 s58, 4
  s_mov_b32 s59, 0x20000
  v_mov_b32 v4, 0
  v_mov_b32 v5, s32
  s_mov_b64 exec, 1
  buffer_store_dword v5, v4, s[56:59], 0 offen
  s_mov_b64 exec, -1
KA_NOSEED:
  s_endpgm
KA_W1:
  s_cmp_eq_u32 s33, 1
  s_cbranch_scc0 KA_W2
  ds_write_b128 v20, v[112:115] offset:21248
  ds_write_b128 v20, v[116:119] offset:24320
  ds_write_b128 v20, v[128:131] offset:35584
  ds_write_b128 v20, v[132:135] offset:38656
  ds_write_b128 v20, v[136:139] offset:40704
  ds_write_b128 v20, v[140:143] offset:43776
  s_waitcnt lgkmcnt(0)
  s_barrier
  ds_read_b128 v[48:51], v20 offset:27392
  ds_read_b128 v[52:55], v20 offset:28416
  ds_read_b128 v[56:59], v20 offset:29440
  ds_read_b64 v[60:61], v19 offset:0
  ds_read_b128 v[64:67], v20 offset:30464
  ds_read_b128 v[68:71], v20 offset:31488
  ds_read_b128 v[72:75], v20 offset:32512
  ds_read_b64 v[76:77], v19 offset:512
  s_waitcnt vmcnt(4) lgkmcnt(0)
  v_pk_add_f32 v[120:121], v[120:121], v[48:49]
  v_pk_add_f32 v[122:123], v[122:123], v[50:51]
  v_pk_add_f32 v[120:121], v[120:121], v[52:53]
  v_pk_add_f32 v[122:123], v[122:123], v[54:55]
  v_pk_add_f32 v[120:121], v[120:121], v[56:57]
  v_pk_add_f32 v[122:123], v[122:123], v[58:59]
  v_lshlrev_b32 v80, 16, v60
  v_and_b32 v81, 0xffff0000, v60
  v_lshlrev_b32 v82, 16, v61
  v_and_b32 v83, 0xffff0000, v61
  v_lshlrev_b32 v84, 16, v28
  v_and_b32 v85, 0xffff0000, v28
  v_lshlrev_b32 v86, 16, v29
  v_and_b32 v87, 0xffff0000, v29
  v_pk_fma_f32 v[120:121], v[80:81], s[34:35], v[120:121]
  v_pk_fma_f32 v[122:123], v[82:83], s[34:35], v[122:123]
  v_pk_fma_f32 v[88:89], v[84:85], v[32:33], v[40:41]
  v_pk_fma_f32 v[90:91], v[86:87], v[34:35], v[42:43]
  v_pk_fma_f32 v[88:89], v[88:89], v[120:121], v[84:85]
  v_pk_fma_f32 v[90:91], v[90:91], v[122:123], v[86:87]
  v_cvt_pk_bf16_f32 v92, v88, v89
  v_cvt_pk_bf16_f32 v93, v90, v91
  buffer_store_dwordx2 v[92:93], v21, s[28:31], 0 offen offset:0 sc1
  v_pk_add_f32 v[124:125], v[124:125], v[64:65]
  v_pk_add_f32 v[126:127], v[126:127], v[66:67]
  v_pk_add_f32 v[124:125], v[124:125], v[68:69]
  v_pk_add_f32 v[126:127], v[126:127], v[70:71]
  v_pk_add_f32 v[124:125], v[124:125], v[72:73]
  v_pk_add_f32 v[126:127], v[126:127], v[74:75]
  v_lshlrev_b32 v80, 16, v76
  v_and_b32 v81, 0xffff0000, v76
  v_lshlrev_b32 v82, 16, v77
  v_and_b32 v83, 0xffff0000, v77
  v_lshlrev_b32 v84, 16, v30
  v_and_b32 v85, 0xffff0000, v30
  v_lshlrev_b32 v86, 16, v31
  v_and_b32 v87, 0xffff0000, v31
  v_pk_fma_f32 v[124:125], v[80:81], s[34:35], v[124:125]
  v_pk_fma_f32 v[126:127], v[82:83], s[34:35], v[126:127]
  v_pk_fma_f32 v[88:89], v[84:85], v[36:37], v[44:45]
  v_pk_fma_f32 v[90:91], v[86:87], v[38:39], v[46:47]
  v_pk_fma_f32 v[88:89], v[88:89], v[124:125], v[84:85]
  v_pk_fma_f32 v[90:91], v[90:91], v[126:127], v[86:87]
  v_cvt_pk_bf16_f32 v94, v88, v89
  v_cvt_pk_bf16_f32 v95, v90, v91
  buffer_store_dwordx2 v[94:95], v21, s[28:31], 0 offen offset:512 sc1
  s_endpgm
KA_W2:
  s_cmp_eq_u32 s33, 2
  s_cbranch_scc0 KA_W3
  ds_write_b128 v20, v[112:115] offset:22272
  ds_write_b128 v20, v[116:119] offset:25344
  ds_write_b128 v20, v[120:123] offset:27392
  ds_write_b128 v20, v[124:127] offset:30464
  ds_write_b128 v20, v[136:139] offset:41728
  ds_write_b128 v20, v[140:143] offset:44800
  s_waitcnt lgkmcnt(0)
  s_barrier
  ds_read_b128 v[48:51], v20 offset:33536
  ds_read_b128 v[52:55], v20 offset:34560
  ds_read_b128 v[56:59], v20 offset:35584
  ds_read_b64 v[60:61], v19 offset:0
  ds_read_b128 v[64:67], v20 offset:36608
  ds_read_b128 v[68:71], v20 offset:37632
  ds_read_b128 v[72:75], v20 offset:38656
  ds_read_b64 v[76:77], v19 offset:512
  s_waitcnt vmcnt(4) lgkmcnt(0)
  v_pk_add_f32 v[128:129], v[128:129], v[48:49]
  v_pk_add_f32 v[130:131], v[130:131], v[50:51]
  v_pk_add_f32 v[128:129], v[128:129], v[52:53]
  v_pk_add_f32 v[130:131], v[130:131], v[54:55]
  v_pk_add_f32 v[128:129], v[128:129], v[56:57]
  v_pk_add_f32 v[130:131], v[130:131], v[58:59]
  v_lshlrev_b32 v80, 16, v60
  v_and_b32 v81, 0xffff0000, v60
  v_lshlrev_b32 v82, 16, v61
  v_and_b32 v83, 0xffff0000, v61
  v_lshlrev_b32 v84, 16, v28
  v_and_b32 v85, 0xffff0000, v28
  v_lshlrev_b32 v86, 16, v29
  v_and_b32 v87, 0xffff0000, v29
  v_pk_fma_f32 v[128:129], v[80:81], s[34:35], v[128:129]
  v_pk_fma_f32 v[130:131], v[82:83], s[34:35], v[130:131]
  v_pk_fma_f32 v[88:89], v[84:85], v[32:33], v[40:41]
  v_pk_fma_f32 v[90:91], v[86:87], v[34:35], v[42:43]
  v_pk_fma_f32 v[88:89], v[88:89], v[128:129], v[84:85]
  v_pk_fma_f32 v[90:91], v[90:91], v[130:131], v[86:87]
  v_cvt_pk_bf16_f32 v92, v88, v89
  v_cvt_pk_bf16_f32 v93, v90, v91
  buffer_store_dwordx2 v[92:93], v21, s[28:31], 0 offen offset:0 sc1
  v_pk_add_f32 v[132:133], v[132:133], v[64:65]
  v_pk_add_f32 v[134:135], v[134:135], v[66:67]
  v_pk_add_f32 v[132:133], v[132:133], v[68:69]
  v_pk_add_f32 v[134:135], v[134:135], v[70:71]
  v_pk_add_f32 v[132:133], v[132:133], v[72:73]
  v_pk_add_f32 v[134:135], v[134:135], v[74:75]
  v_lshlrev_b32 v80, 16, v76
  v_and_b32 v81, 0xffff0000, v76
  v_lshlrev_b32 v82, 16, v77
  v_and_b32 v83, 0xffff0000, v77
  v_lshlrev_b32 v84, 16, v30
  v_and_b32 v85, 0xffff0000, v30
  v_lshlrev_b32 v86, 16, v31
  v_and_b32 v87, 0xffff0000, v31
  v_pk_fma_f32 v[132:133], v[80:81], s[34:35], v[132:133]
  v_pk_fma_f32 v[134:135], v[82:83], s[34:35], v[134:135]
  v_pk_fma_f32 v[88:89], v[84:85], v[36:37], v[44:45]
  v_pk_fma_f32 v[90:91], v[86:87], v[38:39], v[46:47]
  v_pk_fma_f32 v[88:89], v[88:89], v[132:133], v[84:85]
  v_pk_fma_f32 v[90:91], v[90:91], v[134:135], v[86:87]
  v_cvt_pk_bf16_f32 v94, v88, v89
  v_cvt_pk_bf16_f32 v95, v90, v91
  buffer_store_dwordx2 v[94:95], v21, s[28:31], 0 offen offset:512 sc1
  s_endpgm
KA_W3:
  ds_write_b128 v20, v[112:115] offset:23296
  ds_write_b128 v20, v[116:119] offset:26368
  ds_write_b128 v20, v[120:123] offset:28416
  ds_write_b128 v20, v[124:127] offset:31488
  ds_write_b128 v20, v[128:131] offset:33536
  ds_write_b128 v20, v[132:135] offset:36608
  s_waitcnt lgkmcnt(0)
  s_barrier
  ds_read_b128 v[48:51], v20 offset:39680
  ds_read_b128 v[52:55], v20 offset:40704
  ds_read_b128 v[56:59], v20 offset:41728
  ds_read_b64 v[60:61], v19 offset:0
  ds_read_b128 v[64:67], v20 offset:42752
  ds_read_b128 v[68:71], v20 offset:43776
  ds_read_b128 v[72:75], v20 offset:44800
  ds_read_b64 v[76:77], v19 offset:512
  s_waitcnt vmcnt(4) lgkmcnt(0)
  v_pk_add_f32 v[136:137], v[136:137], v[48:49]
  v_pk_add_f32 v[138:139], v[138:139], v[50:51]
  v_pk_add_f32 v[136:137], v[136:137], v[52:53]
  v_pk_add_f32 v[138:139], v[138:139], v[54:55]
  v_pk_add_f32 v[136:137], v[136:137], v[56:57]
  v_pk_add_f32 v[138:139], v[138:139], v[58:59]
  v_lshlrev_b32 v80, 16, v60
  v_and_b32 v81, 0xffff0000, v60
  v_lshlrev_b32 v82, 16, v61
  v_and_b32 v83, 0xffff0000, v61
  v_lshlrev_b32 v84, 16, v28
  v_and_b32 v85, 0xffff0000, v28
  v_lshlrev_b32 v86, 16, v29
  v_and_b32 v87, 0xffff0000, v29
  v_pk_fma_f32 v[136:137], v[80:81], s[34:35], v[136:137]
  v_pk_fma_f32 v[138:139], v[82:83], s[34:35], v[138:139]
  v_pk_fma_f32 v[88:89], v[84:85], v[32:33], v[40:41]
  v_pk_fma_f32 v[90:91], v[86:87], v[34:35], v[42:43]
  v_pk_fma_f32 v[88:89], v[88:89], v[136:137], v[84:85]
  v_pk_fma_f32 v[90:91], v[90:91], v[138:139], v[86:87]
  v_cvt_pk_bf16_f32 v92, v88, v89
  v_cvt_pk_bf16_f32 v93, v90, v91
  buffer_store_dwordx2 v[92:93], v21, s[28:31], 0 offen offset:0 sc1
  v_pk_add_f32 v[140:141], v[140:141], v[64:65]
  v_pk_add_f32 v[142:143], v[142:143], v[66:67]
  v_pk_add_f32 v[140:141], v[140:141], v[68:69]
  v_pk_add_f32 v[142:143], v[142:143], v[70:71]
  v_pk_add_f32 v[140:141], v[140:141], v[72:73]
  v_pk_add_f32 v[142:143], v[142:143], v[74:75]
  v_lshlrev_b32 v80, 16, v76
  v_and_b32 v81, 0xffff0000, v76
  v_lshlrev_b32 v82, 16, v77
  v_and_b32 v83, 0xffff0000, v77
  v_lshlrev_b32 v84, 16, v30
  v_and_b32 v85, 0xffff0000, v30
  v_lshlrev_b32 v86, 16, v31
  v_and_b32 v87, 0xffff0000, v31
  v_pk_fma_f32 v[140:141], v[80:81], s[34:35], v[140:141]
  v_pk_fma_f32 v[142:143], v[82:83], s[34:35], v[142:143]
  v_pk_fma_f32 v[88:89], v[84:85], v[36:37], v[44:45]
  v_pk_fma_f32 v[90:91], v[86:87], v[38:39], v[46:47]
  v_pk_fma_f32 v[88:89], v[88:89], v[140:141], v[84:85]
  v_pk_fma_f32 v[90:91], v[90:91], v[142:143], v[86:87]
  v_cvt_pk_bf16_f32 v94, v88, v89
  v_cvt_pk_bf16_f32 v95, v90, v91
  buffer_store_dwordx2 v[94:95], v21, s[28:31], 0 offen offset:512 sc1
  s_endpgm
KA_END:
  s_endpgm
.globl kb_kernel
.p2align 8
.type kb_kernel,@function
kb_kernel:
  s_cmp_ge_u32 s2, 256
  s_cbranch_scc1 KB_END
  s_load_dwordx4 s[4:7], s[0:1], 56
  s_load_dwordx4 s[8:11], s[0:1], 72
  s_load_dwordx2 s[40:41], s[0:1], 88
  s_load_dwordx2 s[42:43], s[0:1], 104
  s_and_b32 s60, s2, 7
  s_lshr_b32 s61, s2, 3
  s_lshr_b32 s34, s60, 1
  s_lshl_b32 s34, s34, 2
  s_lshr_b32 s62, s61, 3
  s_add_u32 s34, s34, s62
  s_and_b32 s62, s60, 1
  s_lshl_b32 s35, s62, 3
  s_and_b32 s63, s61, 7
  s_add_u32 s35, s35, s63
  s_lshl_b32 s37, s62, 2
  s_and_b32 s63, s61, 3
  s_add_u32 s37, s37, s63
  s_bfe_u32 s36, s61, 0x10002
  s_lshl_b32 s38, s34, 1
  s_add_u32 s38, s38, s36
  v_and_b32 v1, 63, v0
  v_lshrrev_b32 v2, 6, v0
  s_nop 0
  v_readfirstlane_b32 s33, v2
  s_nop 1
  s_cmp_ge_u32 s33, 4
  s_cbranch_scc1 KB_LOADER
  v_lshrrev_b32 v3, 4, v1
  v_bfe_u32 v4, v1, 2, 2
  v_and_b32 v5, 3, v1
  v_lshl_add_u32 v6, v3, 2, v4
  v_and_b32 v7, 7, v6
  s_lshl_b32 s62, s33, 1
  s_add_u32 s63, s62, 0
  v_xor_b32 v8, s63, v7
  v_lshlrev_b32 v8, 5, v8
  v_lshl_add_u32 v8, v6, 8, v8
  v_lshl_add_u32 v10, v5, 3, v8
  s_add_u32 s63, s62, 1
  v_xor_b32 v8, s63, v7
  v_lshlrev_b32 v8, 5, v8
  v_lshl_add_u32 v8, v6, 8, v8
  v_lshl_add_u32 v11, v5, 3, v8
  v_lshlrev_b32 v12, 4, v1
  v_add_u32 v12, 16384, v12
  s_mul_i32 s63, s35, 96
  v_lshl_add_u32 v14, v3, 2, s63
  v_lshlrev_b32 v15, 1, v14
  v_lshlrev_b32 v16, 2, v14
  v_and_b32 v8, 15, v1
  v_mul_u32_u24 v8, 6144, v8
  v_add_u32 v16, v8, v16
  s_lshl_b32 s63, s34, 3
  s_add_u32 s63, s63, s62
  s_mul_i32 s63, s63, 48
  s_mul_i32 s39, s35, 3
  s_add_u32 s63, s63, s39
  s_lshl_b32 s63, s63, 10
  v_lshl_add_u32 v17, v1, 4, s63
  v_lshlrev_b32 v19, 4, v1
  v_lshlrev_b32 v18, 4, v1
  s_and_b32 s62, s33, 1
  s_lshr_b32 s63, s33, 1
  s_lshl_b32 s39, s38, 2
  s_lshl_b32 s60, s62, 1
  s_add_u32 s39, s39, s60
  s_mul_i32 s61, s39, 49152
  s_lshl_b32 s60, s63, 10
  s_add_u32 s61, s61, s60
  v_lshl_add_u32 v56, v1, 4, s61
  s_add_u32 s39, s39, s63
  s_lshl_b32 s62, s62, 1
  s_add_u32 s62, s62, s63
  s_mul_i32 s63, s37, 80
  v_lshl_add_u32 v57, v3, 2, s63
  v_lshlrev_b32 v57, 1, v57
  v_lshlrev_b32 v58, 7, v6
  v_lshl_add_u32 v58, v5, 3, v58
  s_lshl_b32 s63, s62, 5
  s_add_u32 s63, s63, 153600
  v_add_u32 v58, s63, v58
  v_and_b32 v59, 15, v1
  s_lshl_b32 s63, s39, 4
  v_add_u32 v59, s63, v59
  s_movk_i32 s63, 1280
  v_mul_lo_u32 v59, v59, s63
  v_add_u32 v59, v59, v57
  v_mov_b32 v7, v57
  v_mov_b32 v8, 0
  v_mov_b32 v9, 153600
  ds_write_b32 v9, v8
  v_mov_b32 v192, 0x3f803f80
  v_mov_b32 v193, 0x3f803f80
  v_mov_b32 v194, 0x3f803f80
  v_mov_b32 v195, 0x3f803f80
  s_waitcnt lgkmcnt(0)
  s_mov_b32 s32, 8028160
  s_load_dword s32, s[42:43], s32
  s_mov_b32 s16, s6
  s_and_b32 s17, s7, 0xffff
  s_mov_b32 s18, 3072
  s_mov_b32 s19, 0x20000
  s_add_u32 s24, s42, 7929856
  s_addc_u32 s25, s43, 0
  s_and_b32 s25, s25, 0xffff
  s_mov_b32 s26, 61440
  s_mov_b32 s27, 0x20000
  s_add_u32 s28, s42, 8388608
  s_addc_u32 s29, s43, 0
  s_and_b32 s29, s29, 0xffff
  s_mov_b32 s30, 6291456
  s_mov_b32 s31, 0x20000
  s_mov_b32 s48, s10
  s_and_b32 s49, s11, 0xffff
  s_mov_b32 s50, 1280
  s_mov_b32 s51, 0x20000
  s_mov_b32 s52, s40
  s_and_b32 s53, s41, 0xffff
  s_mov_b32 s54, 2621440
  s_mov_b32 s55, 0x20000
  s_add_u32 s56, s42, 8060928
  s_addc_u32 s57, s43, 0
  s_and_b32 s57, s57, 0xffff
  s_mov_b32 s58, 32768
  s_mov_b32 s59, 0x20000
  buffer_load_dwordx2 v[20:21], v15, s[16:19], 0 offen offset:0
  buffer_load_dwordx2 v[22:23], v15, s[16:19], 0 offen offset:32
  buffer_load_dwordx2 v[24:25], v15, s[16:19], 0 offen offset:64
  buffer_load_dwordx2 v[26:27], v15, s[16:19], 0 offen offset:96
  buffer_load_dwordx2 v[28:29], v15, s[16:19], 0 offen offset:128
  buffer_load_dwordx2 v[30:31], v15, s[16:19], 0 offen offset:160
  buffer_load_dwordx4 v[32:35], v16, s[24:27], 0 offen offset:0
  buffer_load_dwordx4 v[36:39], v16, s[24:27], 0 offen offset:64
  buffer_load_dwordx4 v[40:43], v16, s[24:27], 0 offen offset:128
  buffer_load_dwordx4 v[44:47], v16, s[24:27], 0 offen offset:192
  buffer_load_dwordx4 v[48:51], v16, s[24:27], 0 offen offset:256
  buffer_load_dwordx4 v[52:55], v16, s[24:27], 0 offen offset:320
  v_and_b32 v8, 1, v1
  v_cmp_ne_u32 s[4:5], 0, v8
  v_and_b32 v8, 2, v1
  v_cmp_ne_u32 s[6:7], 0, v8
  v_bfe_u32 v8, v1, 2, 2
  v_cmp_eq_u32 s[8:9], v8, v3
  s_barrier
  v_add_u32 v60, 0, v10
  v_add_u32 v61, 0, v11
  v_add_u32 v62, 0, v12
  ds_read_b64_tr_b16 v[88:89], v60 offset:0
  ds_read_b64_tr_b16 v[90:91], v60 offset:4096
  ds_read_b64_tr_b16 v[92:93], v61 offset:0
  ds_read_b64_tr_b16 v[94:95], v61 offset:4096
  ds_read_b128 v[64:67], v62 offset:0
  ds_read_b128 v[68:71], v62 offset:1024
  ds_read_b128 v[72:75], v62 offset:2048
  ds_read_b128 v[76:79], v62 offset:3072
  ds_read_b128 v[80:83], v62 offset:4096
  ds_read_b128 v[84:87], v62 offset:5120
  s_waitcnt lgkmcnt(0)
  v_mfma_f32_16x16x32_bf16 v[184:187], v[88:91], v[88:91], 0
  ds_read_b64_tr_b16 v[120:121], v60 offset:8192
  ds_read_b64_tr_b16 v[122:123], v60 offset:12288
  v_mfma_f32_16x16x32_bf16 v[176:179], v[192:195], v[88:91], 0
  ds_read_b64_tr_b16 v[124:125], v61 offset:8192
  ds_read_b64_tr_b16 v[126:127], v61 offset:12288
  v_mfma_f32_16x16x32_bf16 v[188:191], v[92:95], v[92:95], 0
  ds_read_b128 v[96:99], v62 offset:6144
  ds_read_b128 v[100:103], v62 offset:7168
  v_mfma_f32_16x16x32_bf16 v[180:183], v[192:195], v[92:95], 0
  ds_read_b128 v[104:107], v62 offset:8192
  ds_read_b128 v[108:111], v62 offset:9216
  v_mfma_f32_16x16x32_bf16 v[128:131], v[64:67], v[88:91], 0
  ds_read_b128 v[112:115], v62 offset:10240
  ds_read_b128 v[116:119], v62 offset:11264
  v_mfma_f32_16x16x32_bf16 v[132:135], v[64:67], v[92:95], 0
  v_mfma_f32_16x16x32_bf16 v[136:139], v[68:71], v[88:91], 0
  v_mfma_f32_16x16x32_bf16 v[140:143], v[68:71], v[92:95], 0
  v_mfma_f32_16x16x32_bf16 v[144:147], v[72:75], v[88:91], 0
  v_mfma_f32_16x16x32_bf16 v[148:151], v[72:75], v[92:95], 0
  v_mfma_f32_16x16x32_bf16 v[152:155], v[76:79], v[88:91], 0
  v_mfma_f32_16x16x32_bf16 v[156:159], v[76:79], v[92:95], 0
  v_mfma_f32_16x16x32_bf16 v[160:163], v[80:83], v[88:91], 0
  v_mfma_f32_16x16x32_bf16 v[164:167], v[80:83], v[92:95], 0
  v_mfma_f32_16x16x32_bf16 v[168:171], v[84:87], v[88:91], 0
  v_mfma_f32_16x16x32_bf16 v[172:175], v[84:87], v[92:95], 0
  s_waitcnt lgkmcnt(0)
  s_barrier
  v_add_u32 v60, 30720, v10
  v_add_u32 v61, 30720, v11
  v_add_u32 v62, 30720, v12
  v_mfma_f32_16x16x32_bf16 v[184:187], v[120:123], v[120:123], v[184:187]
  ds_read_b64_tr_b16 v[88:89], v60 offset:0
  ds_read_b64_tr_b16 v[90:91], v60 offset:4096
  v_mfma_f32_16x16x32_bf16 v[176:179], v[192:195], v[120:123], v[176:179]
  ds_read_b64_tr_b16 v[92:93], v61 offset:0
  ds_read_b64_tr_b16 v[94:95], v61 offset:4096
  v_mfma_f32_16x16x32_bf16 v[188:191], v[124:127], v[124:127], v[188:191]
  ds_read_b128 v[64:67], v62 offset:0
  ds_read_b128 v[68:71], v62 offset:1024
  v_mfma_f32_16x16x32_bf16 v[180:183], v[192:195], v[124:127], v[180:183]
  ds_read_b128 v[72:75], v62 offset:2048
  ds_read_b128 v[76:79], v62 offset:3072
  v_mfma_f32_16x16x32_bf16 v[128:131], v[96:99], v[120:123], v[128:131]
  ds_read_b128 v[80:83], v62 offset:4096
  ds_read_b128 v[84:87], v62 offset:5120
  v_mfma_f32_16x16x32_bf16 v[132:135], v[96:99], v[124:127], v[132:135]
  v_mfma_f32_16x16x32_bf16 v[136:139], v[100:103], v[120:123], v[136:139]
  v_mfma_f32_16x16x32_bf16 v[140:143], v[100:103], v[124:127], v[140:143]
  v_mfma_f32_16x16x32_bf16 v[144:147], v[104:107], v[120:123], v[144:147]
  v_mfma_f32_16x16x32_bf16 v[148:151], v[104:107], v[124:127], v[148:151]
  v_mfma_f32_16x16x32_bf16 v[152:155], v[108:111], v[120:123], v[152:155]
  v_mfma_f32_16x16x32_bf16 v[156:159], v[108:111], v[124:127], v[156:159]
  v_mfma_f32_16x16x32_bf16 v[160:163], v[112:115], v[120:123], v[160:163]
  v_mfma_f32_16x16x32_bf16 v[164:167], v[112:115], v[124:127], v[164:167]
  v_mfma_f32_16x16x32_bf16 v[168:171], v[116:119], v[120:123], v[168:171]
  v_mfma_f32_16x16x32_bf16 v[172:175], v[116:119], v[124:127], v[172:175]
  s_waitcnt lgkmcnt(0)
  s_waitcnt vmcnt(0)
  v_mfma_f32_16x16x32_bf16 v[184:187], v[88:91], v[88:91], v[184:187]
  ds_read_b64_tr_b16 v[120:121], v60 offset:8192
  ds_read_b64_tr_b16 v[122:123], v60 offset:12288
  v_mfma_f32_16x16x32_bf16 v[176:179], v[192:195], v[88:91], v[176:179]
  ds_read_b64_tr_b16 v[124:125], v61 offset:8192
  ds_read_b64_tr_b16 v[126:127], v61 offset:12288
  v_mfma_f32_16x16x32_bf16 v[188:191], v[92:95], v[92:95], v[188:191]
  ds_read_b128 v[96:99], v62 offset:6144
  ds_read_b128 v[100:103], v62 offset:7168
  v_mfma_f32_16x16x32_bf16 v[180:183], v[192:195], v[92:95], v[180:183]
  ds_read_b128 v[104:107], v62 offset:8192
  ds_read_b128 v[108:111], v62 offset:9216
  v_mfma_f32_16x16x32_bf16 v[128:131], v[64:67], v[88:91], v[128:131]
  ds_read_b128 v[112:115], v62 offset:10240
  ds_read_b128 v[116:119], v62 offset:11264
  v_mfma_f32_16x16x32_bf16 v[132:135], v[64:67], v[92:95], v[132:135]
  v_add_f32_dpp v32, v32, v32 row_ror:8 row_mask:0xf bank_mask:0xf
  v_mfma_f32_16x16x32_bf16 v[136:139], v[68:71], v[88:91], v[136:139]
  v_add_f32_dpp v33, v33, v33 row_ror:8 row_mask:0xf bank_mask:0xf
  v_mfma_f32_16x16x32_bf16 v[140:143], v[68:71], v[92:95], v[140:143]
  v_mfma_f32_16x16x32_bf16 v[144:147], v[72:75], v[88:91], v[144:147]
  v_add_f32_dpp v34, v34, v34 row_ror:8 row_mask:0xf bank_mask:0xf
  v_mfma_f32_16x16x32_bf16 v[148:151], v[72:75], v[92:95], v[148:151]
  v_mfma_f32_16x16x32_bf16 v[152:155], v[76:79], v[88:91], v[152:155]
  v_add_f32_dpp v35, v35, v35 row_ror:8 row_mask:0xf bank_mask:0xf
  v_mfma_f32_16x16x32_bf16 v[156:159], v[76:79], v[92:95], v[156:159]
  v_mfma_f32_16x16x32_bf16 v[160:163], v[80:83], v[88:91], v[160:163]
  v_add_f32_dpp v36, v36, v36 row_ror:8 row_mask:0xf bank_mask:0xf
  v_mfma_f32_16x16x32_bf16 v[164:167], v[80:83], v[92:95], v[164:167]
  v_mfma_f32_16x16x32_bf16 v[168:171], v[84:87], v[88:91], v[168:171]
  v_add_f32_dpp v37, v37, v37 row_ror:8 row_mask:0xf bank_mask:0xf
  v_mfma_f32_16x16x32_bf16 v[172:175], v[84:87], v[92:95], v[172:175]
  s_waitcnt lgkmcnt(0)
  s_barrier
  v_add_u32 v60, 61440, v10
  v_add_u32 v61, 61440, v11
  v_add_u32 v62, 61440, v12
  v_mfma_f32_16x16x32_bf16 v[184:187], v[120:123], v[120:123], v[184:187]
  ds_read_b64_tr_b16 v[88:89], v60 offset:0
  ds_read_b64_tr_b16 v[90:91], v60 offset:4096
  v_mfma_f32_16x16x32_bf16 v[176:179], v[192:195], v[120:123], v[176:179]
  ds_read_b64_tr_b16 v[92:93], v61 offset:0
  ds_read_b64_tr_b16 v[94:95], v61 offset:4096
  v_mfma_f32_16x16x32_bf16 v[188:191], v[124:127], v[124:127], v[188:191]
  ds_read_b128 v[64:67], v62 offset:0
  ds_read_b128 v[68:71], v62 offset:1024
  v_mfma_f32_16x16x32_bf16 v[180:183], v[192:195], v[124:127], v[180:183]
  ds_read_b128 v[72:75], v62 offset:2048
  ds_read_b128 v[76:79], v62 offset:3072
  v_mfma_f32_16x16x32_bf16 v[128:131], v[96:99], v[120:123], v[128:131]
  ds_read_b128 v[80:83], v62 offset:4096
  ds_read_b128 v[84:87], v62 offset:5120
  v_mfma_f32_16x16x32_bf16 v[132:135], v[96:99], v[124:127], v[132:135]
  v_add_f32_dpp v38, v38, v38 row_ror:8 row_mask:0xf bank_mask:0xf
  v_mfma_f32_16x16x32_bf16 v[136:139], v[100:103], v[120:123], v[136:139]
  v_add_f32_dpp v39, v39, v39 row_ror:8 row_mask:0xf bank_mask:0xf
  v_mfma_f32_16x16x32_bf16 v[140:143], v[100:103], v[124:127], v[140:143]
  v_mfma_f32_16x16x32_bf16 v[144:147], v[104:107], v[120:123], v[144:147]
  v_add_f32_dpp v40, v40, v40 row_ror:8 row_mask:0xf bank_mask:0xf
  v_mfma_f32_16x16x32_bf16 v[148:151], v[104:107], v[124:127], v[148:151]
  v_mfma_f32_16x16x32_bf16 v[152:155], v[108:111], v[120:123], v[152:155]
  v_add_f32_dpp v41, v41, v41 row_ror:8 row_mask:0xf bank_mask:0xf
  v_mfma_f32_16x16x32_bf16 v[156:159], v[108:111], v[124:127], v[156:159]
  v_mfma_f32_16x16x32_bf16 v[160:163], v[112:115], v[120:123], v[160:163]
  v_add_f32_dpp v42, v42, v42 row_ror:8 row_mask:0xf bank_mask:0xf
  v_mfma_f32_16x16x32_bf16 v[164:167], v[112:115], v[124:127], v[164:167]
  v_mfma_f32_16x16x32_bf16 v[168:171], v[116:119], v[120:123], v[168:171]
  v_add_f32_dpp v43, v43, v43 row_ror:8 row_mask:0xf bank_mask:0xf
  v_mfma_f32_16x16x32_bf16 v[172:175], v[116:119], v[124:127], v[172:175]
  s_waitcnt lgkmcnt(0)
  v_mfma_f32_16x16x32_bf16 v[184:187], v[88:91], v[88:91], v[184:187]
  ds_read_b64_tr_b16 v[120:121], v60 offset:8192
  ds_read_b64_tr_b16 v[122:123], v60 offset:12288
  v_mfma_f32_16x16x32_bf16 v[176:179], v[192:195], v[88:91], v[176:179]
  ds_read_b64_tr_b16 v[124:125], v61 offset:8192
  ds_read_b64_tr_b16 v[126:127], v61 offset:12288
  v_mfma_f32_16x16x32_bf16 v[188:191], v[92:95], v[92:95], v[188:191]
  ds_read_b128 v[96:99], v62 offset:6144
  ds_read_b128 v[100:103], v62 offset:7168
  v_mfma_f32_16x16x32_bf16 v[180:183], v[192:195], v[92:95], v[180:183]
  ds_read_b128 v[104:107], v62 offset:8192
  ds_read_b128 v[108:111], v62 offset:9216
  v_mfma_f32_16x16x32_bf16 v[128:131], v[64:67], v[88:91], v[128:131]
  ds_read_b128 v[112:115], v62 offset:10240
  ds_read_b128 v[116:119], v62 offset:11264
  v_mfma_f32_16x16x32_bf16 v[132:135], v[64:67], v[92:95], v[132:135]
  v_add_f32_dpp v44, v44, v44 row_ror:8 row_mask:0xf bank_mask:0xf
  v_mfma_f32_16x16x32_bf16 v[136:139], v[68:71], v[88:91], v[136:139]
  v_add_f32_dpp v45, v45, v45 row_ror:8 row_mask:0xf bank_mask:0xf
  v_mfma_f32_16x16x32_bf16 v[140:143], v[68:71], v[92:95], v[140:143]
  v_mfma_f32_16x16x32_bf16 v[144:147], v[72:75], v[88:91], v[144:147]
  v_add_f32_dpp v46, v46, v46 row_ror:8 row_mask:0xf bank_mask:0xf
  v_mfma_f32_16x16x32_bf16 v[148:151], v[72:75], v[92:95], v[148:151]
  v_mfma_f32_16x16x32_bf16 v[152:155], v[76:79], v[88:91], v[152:155]
  v_add_f32_dpp v47, v47, v47 row_ror:8 row_mask:0xf bank_mask:0xf
  v_mfma_f32_16x16x32_bf16 v[156:159], v[76:79], v[92:95], v[156:159]
  v_mfma_f32_16x16x32_bf16 v[160:163], v[80:83], v[88:91], v[160:163]
  v_add_f32_dpp v48, v48, v48 row_ror:8 row_mask:0xf bank_mask:0xf
  v_mfma_f32_16x16x32_bf16 v[164:167], v[80:83], v[92:95], v[164:167]
  v_mfma_f32_16x16x32_bf16 v[168:171], v[84:87], v[88:91], v[168:171]
  v_add_f32_dpp v49, v49, v49 row_ror:8 row_mask:0xf bank_mask:0xf
  v_mfma_f32_16x16x32_bf16 v[172:175], v[84:87], v[92:95], v[172:175]
  s_waitcnt lgkmcnt(0)
  s_barrier
  v_add_u32 v60, 92160, v10
  v_add_u32 v61, 92160, v11
  v_add_u32 v62, 92160, v12
  v_mfma_f32_16x16x32_bf16 v[184:187], v[120:123], v[120:123], v[184:187]
  ds_read_b64_tr_b16 v[88:89], v60 offset:0
  ds_read_b64_tr_b16 v[90:91], v60 offset:4096
  v_mfma_f32_16x16x32_bf16 v[176:179], v[192:195], v[120:123], v[176:179]
  ds_read_b64_tr_b16 v[92:93], v61 offset:0
  ds_read_b64_tr_b16 v[94:95], v61 offset:4096
  v_mfma_f32_16x16x32_bf16 v[188:191], v[124:127], v[124:127], v[188:191]
  ds_read_b128 v[64:67], v62 offset:0
  ds_read_b128 v[68:71], v62 offset:1024
  v_mfma_f32_16x16x32_bf16 v[180:183], v[192:195], v[124:127], v[180:183]
  ds_read_b128 v[72:75], v62 offset:2048
  ds_read_b128 v[76:79], v62 offset:3072
  v_mfma_f32_16x16x32_bf16 v[128:131], v[96:99], v[120:123], v[128:131]
  ds_read_b128 v[80:83], v62 offset:4096
  ds_read_b128 v[84:87], v62 offset:5120
  v_mfma_f32_16x16x32_bf16 v[132:135], v[96:99], v[124:127], v[132:135]
  v_add_f32_dpp v50, v50, v50 row_ror:8 row_mask:0xf bank_mask:0xf
  v_mfma_f32_16x16x32_bf16 v[136:139], v[100:103], v[120:123], v[136:139]
  v_add_f32_dpp v51, v51, v51 row_ror:8 row_mask:0xf bank_mask:0xf
  v_mfma_f32_16x16x32_bf16 v[140:143], v[100:103], v[124:127], v[140:143]
  v_mfma_f32_16x16x32_bf16 v[144:147], v[104:107], v[120:123], v[144:147]
  v_add_f32_dpp v52, v52, v52 row_ror:8 row_mask:0xf bank_mask:0xf
  v_mfma_f32_16x16x32_bf16 v[148:151], v[104:107], v[124:127], v[148:151]
  v_mfma_f32_16x16x32_bf16 v[152:155], v[108:111], v[120:123], v[152:155]
  v_add_f32_dpp v53, v53, v53 row_ror:8 row_mask:0xf bank_mask:0xf
  v_mfma_f32_16x16x32_bf16 v[156:159], v[108:111], v[124:127], v[156:159]
  v_mfma_f32_16x16x32_bf16 v[160:163], v[112:115], v[120:123], v[160:163]
  v_add_f32_dpp v54, v54, v54 row_ror:8 row_mask:0xf bank_mask:0xf
  v_mfma_f32_16x16x32_bf16 v[164:167], v[112:115], v[124:127], v[164:167]
  v_mfma_f32_16x16x32_bf16 v[168:171], v[116:119], v[120:123], v[168:171]
  v_add_f32_dpp v55, v55, v55 row_ror:8 row_mask:0xf bank_mask:0xf
  v_mfma_f32_16x16x32_bf16 v[172:175], v[116:119], v[124:127], v[172:175]
  s_waitcnt lgkmcnt(0)
  v_mfma_f32_16x16x32_bf16 v[184:187], v[88:91], v[88:91], v[184:187]
  ds_read_b64_tr_b16 v[120:121], v60 offset:8192
  ds_read_b64_tr_b16 v[122:123], v60 offset:12288
  v_mfma_f32_16x16x32_bf16 v[176:179], v[192:195], v[88:91], v[176:179]
  ds_read_b64_tr_b16 v[124:125], v61 offset:8192
  ds_read_b64_tr_b16 v[126:127], v61 offset:12288
  v_mfma_f32_16x16x32_bf16 v[188:191], v[92:95], v[92:95], v[188:191]
  ds_read_b128 v[96:99], v62 offset:6144
  ds_read_b128 v[100:103], v62 offset:7168
  v_mfma_f32_16x16x32_bf16 v[180:183], v[192:195], v[92:95], v[180:183]
  ds_read_b128 v[104:107], v62 offset:8192
  ds_read_b128 v[108:111], v62 offset:9216
  v_mfma_f32_16x16x32_bf16 v[128:131], v[64:67], v[88:91], v[128:131]
  ds_read_b128 v[112:115], v62 offset:10240
  ds_read_b128 v[116:119], v62 offset:11264
  v_mfma_f32_16x16x32_bf16 v[132:135], v[64:67], v[92:95], v[132:135]
  v_add_f32_dpp v32, v32, v32 row_ror:4 row_mask:0xf bank_mask:0xf
  v_mfma_f32_16x16x32_bf16 v[136:139], v[68:71], v[88:91], v[136:139]
  v_add_f32_dpp v33, v33, v33 row_ror:4 row_mask:0xf bank_mask:0xf
  v_mfma_f32_16x16x32_bf16 v[140:143], v[68:71], v[92:95], v[140:143]
  v_mfma_f32_16x16x32_bf16 v[144:147], v[72:75], v[88:91], v[144:147]
  v_add_f32_dpp v34, v34, v34 row_ror:4 row_mask:0xf bank_mask:0xf
  v_mfma_f32_16x16x32_bf16 v[148:151], v[72:75], v[92:95], v[148:151]
  v_mfma_f32_16x16x32_bf16 v[152:155], v[76:79], v[88:91], v[152:155]
  v_add_f32_dpp v35, v35, v35 row_ror:4 row_mask:0xf bank_mask:0xf
  v_mfma_f32_16x16x32_bf16 v[156:159], v[76:79], v[92:95], v[156:159]
  v_mfma_f32_16x16x32_bf16 v[160:163], v[80:83], v[88:91], v[160:163]
  v_add_f32_dpp v36, v36, v36 row_ror:4 row_mask:0xf bank_mask:0xf
  v_mfma_f32_16x16x32_bf16 v[164:167], v[80:83], v[92:95], v[164:167]
  v_mfma_f32_16x16x32_bf16 v[168:171], v[84:87], v[88:91], v[168:171]
  v_add_f32_dpp v37, v37, v37 row_ror:4 row_mask:0xf bank_mask:0xf
  v_mfma_f32_16x16x32_bf16 v[172:175], v[84:87], v[92:95], v[172:175]
  s_waitcnt lgkmcnt(0)
  s_barrier
  v_add_u32 v60, 122880, v10
  v_add_u32 v61, 122880, v11
  v_add_u32 v62, 122880, v12
  v_mfma_f32_16x16x32_bf16 v[184:187], v[120:123], v[120:123], v[184:187]
  ds_read_b64_tr_b16 v[88:89], v60 offset:0
  ds_read_b64_tr_b16 v[90:91], v60 offset:4096
  v_mfma_f32_16x16x32_bf16 v[176:179], v[192:195], v[120:123], v[176:179]
  ds_read_b64_tr_b16 v[92:93], v61 offset:0
  ds_read_b64_tr_b16 v[94:95], v61 offset:4096
  v_mfma_f32_16x16x32_bf16 v[188:191], v[124:127], v[124:127], v[188:191]
  ds_read_b128 v[64:67], v62 offset:0
  ds_read_b128 v[68:71], v62 offset:1024
  v_mfma_f32_16x16x32_bf16 v[180:183], v[192:195], v[124:127], v[180:183]
  ds_read_b128 v[72:75], v62 offset:2048
  ds_read_b128 v[76:79], v62 offset:3072
  v_mfma_f32_16x16x32_bf16 v[128:131], v[96:99], v[120:123], v[128:131]
  ds_read_b128 v[80:83], v62 offset:4096
  ds_read_b128 v[84:87], v62 offset:5120
  v_mfma_f32_16x16x32_bf16 v[132:135], v[96:99], v[124:127], v[132:135]
  v_add_f32_dpp v38, v38, v38 row_ror:4 row_mask:0xf bank_mask:0xf
  v_mfma_f32_16x16x32_bf16 v[136:139], v[100:103], v[120:123], v[136:139]
  v_add_f32_dpp v39, v39, v39 row_ror:4 row_mask:0xf bank_mask:0xf
  v_mfma_f32_16x16x32_bf16 v[140:143], v[100:103], v[124:127], v[140:143]
  v_mfma_f32_16x16x32_bf16 v[144:147], v[104:107], v[120:123], v[144:147]
  v_add_f32_dpp v40, v40, v40 row_ror:4 row_mask:0xf bank_mask:0xf
  v_mfma_f32_16x16x32_bf16 v[148:151], v[104:107], v[124:127], v[148:151]
  v_mfma_f32_16x16x32_bf16 v[152:155], v[108:111], v[120:123], v[152:155]
  v_add_f32_dpp v41, v41, v41 row_ror:4 row_mask:0xf bank_mask:0xf
  v_mfma_f32_16x16x32_bf16 v[156:159], v[108:111], v[124:127], v[156:159]
  v_mfma_f32_16x16x32_bf16 v[160:163], v[112:115], v[120:123], v[160:163]
  v_add_f32_dpp v42, v42, v42 row_ror:4 row_mask:0xf bank_mask:0xf
  v_mfma_f32_16x16x32_bf16 v[164:167], v[112:115], v[124:127], v[164:167]
  v_mfma_f32_16x16x32_bf16 v[168:171], v[116:119], v[120:123], v[168:171]
  v_add_f32_dpp v43, v43, v43 row_ror:4 row_mask:0xf bank_mask:0xf
  v_mfma_f32_16x16x32_bf16 v[172:175], v[116:119], v[124:127], v[172:175]
  s_waitcnt lgkmcnt(0)
  v_mfma_f32_16x16x32_bf16 v[184:187], v[88:91], v[88:91], v[184:187]
  ds_read_b64_tr_b16 v[120:121], v60 offset:8192
  ds_read_b64_tr_b16 v[122:123], v60 offset:12288
  v_mfma_f32_16x16x32_bf16 v[176:179], v[192:195], v[88:91], v[176:179]
  ds_read_b64_tr_b16 v[124:125], v61 offset:8192
  ds_read_b64_tr_b16 v[126:127], v61 offset:12288
  v_mfma_f32_16x16x32_bf16 v[188:191], v[92:95], v[92:95], v[188:191]
  ds_read_b128 v[96:99], v62 offset:6144
  ds_read_b128 v[100:103], v62 offset:7168
  v_mfma_f32_16x16x32_bf16 v[180:183], v[192:195], v[92:95], v[180:183]
  ds_read_b128 v[104:107], v62 offset:8192
  ds_read_b128 v[108:111], v62 offset:9216
  v_mfma_f32_16x16x32_bf16 v[128:131], v[64:67], v[88:91], v[128:131]
  ds_read_b128 v[112:115], v62 offset:10240
  ds_read_b128 v[116:119], v62 offset:11264
  v_mfma_f32_16x16x32_bf16 v[132:135], v[64:67], v[92:95], v[132:135]
  v_add_f32_dpp v44, v44, v44 row_ror:4 row_mask:0xf bank_mask:0xf
  v_mfma_f32_16x16x32_bf16 v[136:139], v[68:71], v[88:91], v[136:139]
  v_add_f32_dpp v45, v45, v45 row_ror:4 row_mask:0xf bank_mask:0xf
  v_mfma_f32_16x16x32_bf16 v[140:143], v[68:71], v[92:95], v[140:143]
  v_mfma_f32_16x16x32_bf16 v[144:147], v[72:75], v[88:91], v[144:147]
  v_add_f32_dpp v46, v46, v46 row_ror:4 row_mask:0xf bank_mask:0xf
  v_mfma_f32_16x16x32_bf16 v[148:151], v[72:75], v[92:95], v[148:151]
  v_mfma_f32_16x16x32_bf16 v[152:155], v[76:79], v[88:91], v[152:155]
  v_add_f32_dpp v47, v47, v47 row_ror:4 row_mask:0xf bank_mask:0xf
  v_mfma_f32_16x16x32_bf16 v[156:159], v[76:79], v[92:95], v[156:159]
  v_mfma_f32_16x16x32_bf16 v[160:163], v[80:83], v[88:91], v[160:163]
  v_add_f32_dpp v48, v48, v48 row_ror:4 row_mask:0xf bank_mask:0xf
  v_mfma_f32_16x16x32_bf16 v[164:167], v[80:83], v[92:95], v[164:167]
  v_mfma_f32_16x16x32_bf16 v[168:171], v[84:87], v[88:91], v[168:171]
  v_add_f32_dpp v49, v49, v49 row_ror:4 row_mask:0xf bank_mask:0xf
  v_mfma_f32_16x16x32_bf16 v[172:175], v[84:87], v[92:95], v[172:175]
  s_waitcnt lgkmcnt(0)
  s_barrier
  v_add_u32 v60, 0, v10
  v_add_u32 v61, 0, v11
  v_add_u32 v62, 0, v12
  v_mfma_f32_16x16x32_bf16 v[184:187], v[120:123], v[120:123], v[184:187]
  ds_read_b64_tr_b16 v[88:89], v60 offset:0
  ds_read_b64_tr_b16 v[90:91], v60 offset:4096
  v_mfma_f32_16x16x32_bf16 v[176:179], v[192:195], v[120:123], v[176:179]
  ds_read_b64_tr_b16 v[92:93], v61 offset:0
  ds_read_b64_tr_b16 v[94:95], v61 offset:4096
  v_mfma_f32_16x16x32_bf16 v[188:191], v[124:127], v[124:127], v[188:191]
  ds_read_b128 v[64:67], v62 offset:0
  ds_read_b128 v[68:71], v62 offset:1024
  v_mfma_f32_16x16x32_bf16 v[180:183], v[192:195], v[124:127], v[180:183]
  ds_read_b128 v[72:75], v62 offset:2048
  ds_read_b128 v[76:79], v62 offset:3072
  v_mfma_f32_16x16x32_bf16 v[128:131], v[96:99], v[120:123], v[128:131]
  ds_read_b128 v[80:83], v62 offset:4096
  ds_read_b128 v[84:87], v62 offset:5120
  v_mfma_f32_16x16x32_bf16 v[132:135], v[96:99], v[124:127], v[132:135]
  v_add_f32_dpp v50, v50, v50 row_ror:4 row_mask:0xf bank_mask:0xf
  v_mfma_f32_16x16x32_bf16 v[136:139], v[100:103], v[120:123], v[136:139]
  v_add_f32_dpp v51, v51, v51 row_ror:4 row_mask:0xf bank_mask:0xf
  v_mfma_f32_16x16x32_bf16 v[140:143], v[100:103], v[124:127], v[140:143]
  v_mfma_f32_16x16x32_bf16 v[144:147], v[104:107], v[120:123], v[144:147]
  v_add_f32_dpp v52, v52, v52 row_ror:4 row_mask:0xf bank_mask:0xf
  v_mfma_f32_16x16x32_bf16 v[148:151], v[104:107], v[124:127], v[148:151]
  v_mfma_f32_16x16x32_bf16 v[152:155], v[108:111], v[120:123], v[152:155]
  v_add_f32_dpp v53, v53, v53 row_ror:4 row_mask:0xf bank_mask:0xf
  v_mfma_f32_16x16x32_bf16 v[156:159], v[108:111], v[124:127], v[156:159]
  v_mfma_f32_16x16x32_bf16 v[160:163], v[112:115], v[120:123], v[160:163]
  v_add_f32_dpp v54, v54, v54 row_ror:4 row_mask:0xf bank_mask:0xf
  v_mfma_f32_16x16x32_bf16 v[164:167], v[112:115], v[124:127], v[164:167]
  v_mfma_f32_16x16x32_bf16 v[168:171], v[116:119], v[120:123], v[168:171]
  v_add_f32_dpp v55, v55, v55 row_ror:4 row_mask:0xf bank_mask:0xf
  v_mfma_f32_16x16x32_bf16 v[172:175], v[116:119], v[124:127], v[172:175]
  s_waitcnt lgkmcnt(0)
  v_mfma_f32_16x16x32_bf16 v[184:187], v[88:91], v[88:91], v[184:187]
  ds_read_b64_tr_b16 v[120:121], v60 offset:8192
  ds_read_b64_tr_b16 v[122:123], v60 offset:12288
  v_mfma_f32_16x16x32_bf16 v[176:179], v[192:195], v[88:91], v[176:179]
  ds_read_b64_tr_b16 v[124:125], v61 offset:8192
  ds_read_b64_tr_b16 v[126:127], v61 offset:12288
  v_mfma_f32_16x16x32_bf16 v[188:191], v[92:95], v[92:95], v[188:191]
  ds_read_b128 v[96:99], v62 offset:6144
  ds_read_b128 v[100:103], v62 offset:7168
  v_mfma_f32_16x16x32_bf16 v[180:183], v[192:195], v[92:95], v[180:183]
  ds_read_b128 v[104:107], v62 offset:8192
  ds_read_b128 v[108:111], v62 offset:9216
  v_mfma_f32_16x16x32_bf16 v[128:131], v[64:67], v[88:91], v[128:131]
  ds_read_b128 v[112:115], v62 offset:10240
  ds_read_b128 v[116:119], v62 offset:11264
  v_mfma_f32_16x16x32_bf16 v[132:135], v[64:67], v[92:95], v[132:135]
  v_add_f32_dpp v32, v32, v32 row_ror:2 row_mask:0xf bank_mask:0xf
  v_mfma_f32_16x16x32_bf16 v[136:139], v[68:71], v[88:91], v[136:139]
  v_add_f32_dpp v33, v33, v33 row_ror:2 row_mask:0xf bank_mask:0xf
  v_mfma_f32_16x16x32_bf16 v[140:143], v[68:71], v[92:95], v[140:143]
  v_mfma_f32_16x16x32_bf16 v[144:147], v[72:75], v[88:91], v[144:147]
  v_add_f32_dpp v34, v34, v34 row_ror:2 row_mask:0xf bank_mask:0xf
  v_mfma_f32_16x16x32_bf16 v[148:151], v[72:75], v[92:95], v[148:151]
  v_mfma_f32_16x16x32_bf16 v[152:155], v[76:79], v[88:91], v[152:155]
  v_add_f32_dpp v35, v35, v35 row_ror:2 row_mask:0xf bank_mask:0xf
  v_mfma_f32_16x16x32_bf16 v[156:159], v[76:79], v[92:95], v[156:159]
  v_mfma_f32_16x16x32_bf16 v[160:163], v[80:83], v[88:91], v[160:163]
  v_add_f32_dpp v36, v36, v36 row_ror:2 row_mask:0xf bank_mask:0xf
  v_mfma_f32_16x16x32_bf16 v[164:167], v[80:83], v[92:95], v[164:167]
  v_mfma_f32_16x16x32_bf16 v[168:171], v[84:87], v[88:91], v[168:171]
  v_add_f32_dpp v37, v37, v37 row_ror:2 row_mask:0xf bank_mask:0xf
  v_mfma_f32_16x16x32_bf16 v[172:175], v[84:87], v[92:95], v[172:175]
  s_waitcnt lgkmcnt(0)
  s_barrier
  v_add_u32 v60, 30720, v10
  v_add_u32 v61, 30720, v11
  v_add_u32 v62, 30720, v12
  v_mfma_f32_16x16x32_bf16 v[184:187], v[120:123], v[120:123], v[184:187]
  ds_read_b64_tr_b16 v[88:89], v60 offset:0
  ds_read_b64_tr_b16 v[90:91], v60 offset:4096
  v_mfma_f32_16x16x32_bf16 v[176:179], v[192:195], v[120:123], v[176:179]
  ds_read_b64_tr_b16 v[92:93], v61 offset:0
  ds_read_b64_tr_b16 v[94:95], v61 offset:4096
  v_mfma_f32_16x16x32_bf16 v[188:191], v[124:127], v[124:127], v[188:191]
  ds_read_b128 v[64:67], v62 offset:0
  ds_read_b128 v[68:71], v62 offset:1024
  v_mfma_f32_16x16x32_bf16 v[180:183], v[192:195], v[124:127], v[180:183]
  ds_read_b128 v[72:75], v62 offset:2048
  ds_read_b128 v[76:79], v62 offset:3072
  v_mfma_f32_16x16x32_bf16 v[128:131], v[96:99], v[120:123], v[128:131]
  ds_read_b128 v[80:83], v62 offset:4096
  ds_read_b128 v[84:87], v62 offset:5120
  v_mfma_f32_16x16x32_bf16 v[132:135], v[96:99], v[124:127], v[132:135]
  v_add_f32_dpp v38, v38, v38 row_ror:2 row_mask:0xf bank_mask:0xf
  v_mfma_f32_16x16x32_bf16 v[136:139], v[100:103], v[120:123], v[136:139]
  v_add_f32_dpp v39, v39, v39 row_ror:2 row_mask:0xf bank_mask:0xf
  v_mfma_f32_16x16x32_bf16 v[140:143], v[100:103], v[124:127], v[140:143]
  v_mfma_f32_16x16x32_bf16 v[144:147], v[104:107], v[120:123], v[144:147]
  v_add_f32_dpp v40, v40, v40 row_ror:2 row_mask:0xf bank_mask:0xf
  v_mfma_f32_16x16x32_bf16 v[148:151], v[104:107], v[124:127], v[148:151]
  v_mfma_f32_16x16x32_bf16 v[152:155], v[108:111], v[120:123], v[152:155]
  v_add_f32_dpp v41, v41, v41 row_ror:2 row_mask:0xf bank_mask:0xf
  v_mfma_f32_16x16x32_bf16 v[156:159], v[108:111], v[124:127], v[156:159]
  v_mfma_f32_16x16x32_bf16 v[160:163], v[112:115], v[120:123], v[160:163]
  v_add_f32_dpp v42, v42, v42 row_ror:2 row_mask:0xf bank_mask:0xf
  v_mfma_f32_16x16x32_bf16 v[164:167], v[112:115], v[124:127], v[164:167]
  v_mfma_f32_16x16x32_bf16 v[168:171], v[116:119], v[120:123], v[168:171]
  v_add_f32_dpp v43, v43, v43 row_ror:2 row_mask:0xf bank_mask:0xf
  v_mfma_f32_16x16x32_bf16 v[172:175], v[116:119], v[124:127], v[172:175]
  s_waitcnt lgkmcnt(0)
  v_mfma_f32_16x16x32_bf16 v[184:187], v[88:91], v[88:91], v[184:187]
  ds_read_b64_tr_b16 v[120:121], v60 offset:8192
  ds_read_b64_tr_b16 v[122:123], v60 offset:12288
  v_mfma_f32_16x16x32_bf16 v[176:179], v[192:195], v[88:91], v[176:179]
  ds_read_b64_tr_b16 v[124:125], v61 offset:8192
  ds_read_b64_tr_b16 v[126:127], v61 offset:12288
  v_mfma_f32_16x16x32_bf16 v[188:191], v[92:95], v[92:95], v[188:191]
  ds_read_b128 v[96:99], v62 offset:6144
  ds_read_b128 v[100:103], v62 offset:7168
  v_mfma_f32_16x16x32_bf16 v[180:183], v[192:195], v[92:95], v[180:183]
  ds_read_b128 v[104:107], v62 offset:8192
  ds_read_b128 v[108:111], v62 offset:9216
  v_mfma_f32_16x16x32_bf16 v[128:131], v[64:67], v[88:91], v[128:131]
  ds_read_b128 v[112:115], v62 offset:10240
  ds_read_b128 v[116:119], v62 offset:11264
  v_mfma_f32_16x16x32_bf16 v[132:135], v[64:67], v[92:95], v[132:135]
  v_add_f32_dpp v44, v44, v44 row_ror:2 row_mask:0xf bank_mask:0xf
  v_mfma_f32_16x16x32_bf16 v[136:139], v[68:71], v[88:91], v[136:139]
  v_add_f32_dpp v45, v45, v45 row_ror:2 row_mask:0xf bank_mask:0xf
  v_mfma_f32_16x16x32_bf16 v[140:143], v[68:71], v[92:95], v[140:143]
  v_mfma_f32_16x16x32_bf16 v[144:147], v[72:75], v[88:91], v[144:147]
  v_add_f32_dpp v46, v46, v46 row_ror:2 row_mask:0xf bank_mask:0xf
  v_mfma_f32_16x16x32_bf16 v[148:151], v[72:75], v[92:95], v[148:151]
  v_mfma_f32_16x16x32_bf16 v[152:155], v[76:79], v[88:91], v[152:155]
  v_add_f32_dpp v47, v47, v47 row_ror:2 row_mask:0xf bank_mask:0xf
  v_mfma_f32_16x16x32_bf16 v[156:159], v[76:79], v[92:95], v[156:159]
  v_mfma_f32_16x16x32_bf16 v[160:163], v[80:83], v[88:91], v[160:163]
  v_add_f32_dpp v48, v48, v48 row_ror:2 row_mask:0xf bank_mask:0xf
  v_mfma_f32_16x16x32_bf16 v[164:167], v[80:83], v[92:95], v[164:167]
  v_mfma_f32_16x16x32_bf16 v[168:171], v[84:87], v[88:91], v[168:171]
  v_add_f32_dpp v49, v49, v49 row_ror:2 row_mask:0xf bank_mask:0xf
  v_mfma_f32_16x16x32_bf16 v[172:175], v[84:87], v[92:95], v[172:175]
  s_waitcnt lgkmcnt(0)
  s_barrier
  v_add_u32 v60, 61440, v10
  v_add_u32 v61, 61440, v11
  v_add_u32 v62, 61440, v12
  v_mfma_f32_16x16x32_bf16 v[184:187], v[120:123], v[120:123], v[184:187]
  ds_read_b64_tr_b16 v[88:89], v60 offset:0
  ds_read_b64_tr_b16 v[90:91], v60 offset:4096
  v_mfma_f32_16x16x32_bf16 v[176:179], v[192:195], v[120:123], v[176:179]
  ds_read_b64_tr_b16 v[92:93], v61 offset:0
  ds_read_b64_tr_b16 v[94:95], v61 offset:4096
  v_mfma_f32_16x16x32_bf16 v[188:191], v[124:127], v[124:127], v[188:191]
  ds_read_b128 v[64:67], v62 offset:0
  ds_read_b128 v[68:71], v62 offset:1024
  v_mfma_f32_16x16x32_bf16 v[180:183], v[192:195], v[124:127], v[180:183]
  ds_read_b128 v[72:75], v62 offset:2048
  ds_read_b128 v[76:79], v62 offset:3072
  v_mfma_f32_16x16x32_bf16 v[128:131], v[96:99], v[120:123], v[128:131]
  ds_read_b128 v[80:83], v62 offset:4096
  ds_read_b128 v[84:87], v62 offset:5120
  v_mfma_f32_16x16x32_bf16 v[132:135], v[96:99], v[124:127], v[132:135]
  v_add_f32_dpp v50, v50, v50 row_ror:2 row_mask:0xf bank_mask:0xf
  v_mfma_f32_16x16x32_bf16 v[136:139], v[100:103], v[120:123], v[136:139]
  v_add_f32_dpp v51, v51, v51 row_ror:2 row_mask:0xf bank_mask:0xf
  v_mfma_f32_16x16x32_bf16 v[140:143], v[100:103], v[124:127], v[140:143]
  v_mfma_f32_16x16x32_bf16 v[144:147], v[104:107], v[120:123], v[144:147]
  v_add_f32_dpp v52, v52, v52 row_ror:2 row_mask:0xf bank_mask:0xf
  v_mfma_f32_16x16x32_bf16 v[148:151], v[104:107], v[124:127], v[148:151]
  v_mfma_f32_16x16x32_bf16 v[152:155], v[108:111], v[120:123], v[152:155]
  v_add_f32_dpp v53, v53, v53 row_ror:2 row_mask:0xf bank_mask:0xf
  v_mfma_f32_16x16x32_bf16 v[156:159], v[108:111], v[124:127], v[156:159]
  v_mfma_f32_16x16x32_bf16 v[160:163], v[112:115], v[120:123], v[160:163]
  v_add_f32_dpp v54, v54, v54 row_ror:2 row_mask:0xf bank_mask:0xf
  v_mfma_f32_16x16x32_bf16 v[164:167], v[112:115], v[124:127], v[164:167]
  v_mfma_f32_16x16x32_bf16 v[168:171], v[116:119], v[120:123], v[168:171]
  v_add_f32_dpp v55, v55, v55 row_ror:2 row_mask:0xf bank_mask:0xf
  v_mfma_f32_16x16x32_bf16 v[172:175], v[116:119], v[124:127], v[172:175]
  s_waitcnt lgkmcnt(0)
  v_mfma_f32_16x16x32_bf16 v[184:187], v[88:91], v[88:91], v[184:187]
  ds_read_b64_tr_b16 v[120:121], v60 offset:8192
  ds_read_b64_tr_b16 v[122:123], v60 offset:12288
  v_mfma_f32_16x16x32_bf16 v[176:179], v[192:195], v[88:91], v[176:179]
  ds_read_b64_tr_b16 v[124:125], v61 offset:8192
  ds_read_b64_tr_b16 v[126:127], v61 offset:12288
  v_mfma_f32_16x16x32_bf16 v[188:191], v[92:95], v[92:95], v[188:191]
  ds_read_b128 v[96:99], v62 offset:6144
  ds_read_b128 v[100:103], v62 offset:7168
  v_mfma_f32_16x16x32_bf16 v[180:183], v[192:195], v[92:95], v[180:183]
  ds_read_b128 v[104:107], v62 offset:8192
  ds_read_b128 v[108:111], v62 offset:9216
  v_mfma_f32_16x16x32_bf16 v[128:131], v[64:67], v[88:91], v[128:131]
  ds_read_b128 v[112:115], v62 offset:10240
  ds_read_b128 v[116:119], v62 offset:11264
  v_mfma_f32_16x16x32_bf16 v[132:135], v[64:67], v[92:95], v[132:135]
  v_add_f32_dpp v32, v32, v32 row_ror:1 row_mask:0xf bank_mask:0xf
  v_mfma_f32_16x16x32_bf16 v[136:139], v[68:71], v[88:91], v[136:139]
  v_add_f32_dpp v33, v33, v33 row_ror:1 row_mask:0xf bank_mask:0xf
  v_mfma_f32_16x16x32_bf16 v[140:143], v[68:71], v[92:95], v[140:143]
  v_mfma_f32_16x16x32_bf16 v[144:147], v[72:75], v[88:91], v[144:147]
  v_add_f32_dpp v34, v34, v34 row_ror:1 row_mask:0xf bank_mask:0xf
  v_mfma_f32_16x16x32_bf16 v[148:151], v[72:75], v[92:95], v[148:151]
  v_mfma_f32_16x16x32_bf16 v[152:155], v[76:79], v[88:91], v[152:155]
  v_add_f32_dpp v35, v35, v35 row_ror:1 row_mask:0xf bank_mask:0xf
  v_mfma_f32_16x16x32_bf16 v[156:159], v[76:79], v[92:95], v[156:159]
  v_mfma_f32_16x16x32_bf16 v[160:163], v[80:83], v[88:91], v[160:163]
  v_add_f32_dpp v36, v36, v36 row_ror:1 row_mask:0xf bank_mask:0xf
  v_mfma_f32_16x16x32_bf16 v[164:167], v[80:83], v[92:95], v[164:167]
  v_mfma_f32_16x16x32_bf16 v[168:171], v[84:87], v[88:91], v[168:171]
  v_add_f32_dpp v37, v37, v37 row_ror:1 row_mask:0xf bank_mask:0xf
  v_mfma_f32_16x16x32_bf16 v[172:175], v[84:87], v[92:95], v[172:175]
  s_waitcnt lgkmcnt(0)
  s_barrier
  v_add_u32 v60, 92160, v10
  v_add_u32 v61, 92160, v11
  v_add_u32 v62, 92160, v12
  v_mfma_f32_16x16x32_bf16 v[184:187], v[120:123], v[120:123], v[184:187]
  ds_read_b64_tr_b16 v[88:89], v60 offset:0
  ds_read_b64_tr_b16 v[90:91], v60 offset:4096
  v_mfma_f32_16x16x32_bf16 v[176:179], v[192:195], v[120:123], v[176:179]
  ds_read_b64_tr_b16 v[92:93], v61 offset:0
  ds_read_b64_tr_b16 v[94:95], v61 offset:4096
  v_mfma_f32_16x16x32_bf16 v[188:191], v[124:127], v[124:127], v[188:191]
  ds_read_b128 v[64:67], v62 offset:0
  ds_read_b128 v[68:71], v62 offset:1024
  v_mfma_f32_16x16x32_bf16 v[180:183], v[192:195], v[124:127], v[180:183]
  ds_read_b128 v[72:75], v62 offset:2048
  ds_read_b128 v[76:79], v62 offset:3072
  v_mfma_f32_16x16x32_bf16 v[128:131], v[96:99], v[120:123], v[128:131]
  ds_read_b128 v[80:83], v62 offset:4096
  ds_read_b128 v[84:87], v62 offset:5120
  v_mfma_f32_16x16x32_bf16 v[132:135], v[96:99], v[124:127], v[132:135]
  v_add_f32_dpp v38, v38, v38 row_ror:1 row_mask:0xf bank_mask:0xf
  v_mfma_f32_16x16x32_bf16 v[136:139], v[100:103], v[120:123], v[136:139]
  v_add_f32_dpp v39, v39, v39 row_ror:1 row_mask:0xf bank_mask:0xf
  v_mfma_f32_16x16x32_bf16 v[140:143], v[100:103], v[124:127], v[140:143]
  v_mfma_f32_16x16x32_bf16 v[144:147], v[104:107], v[120:123], v[144:147]
  v_add_f32_dpp v40, v40, v40 row_ror:1 row_mask:0xf bank_mask:0xf
  v_mfma_f32_16x16x32_bf16 v[148:151], v[104:107], v[124:127], v[148:151]
  v_mfma_f32_16x16x32_bf16 v[152:155], v[108:111], v[120:123], v[152:155]
  v_add_f32_dpp v41, v41, v41 row_ror:1 row_mask:0xf bank_mask:0xf
  v_mfma_f32_16x16x32_bf16 v[156:159], v[108:111], v[124:127], v[156:159]
  v_mfma_f32_16x16x32_bf16 v[160:163], v[112:115], v[120:123], v[160:163]
  v_add_f32_dpp v42, v42, v42 row_ror:1 row_mask:0xf bank_mask:0xf
  v_mfma_f32_16x16x32_bf16 v[164:167], v[112:115], v[124:127], v[164:167]
  v_mfma_f32_16x16x32_bf16 v[168:171], v[116:119], v[120:123], v[168:171]
  v_add_f32_dpp v43, v43, v43 row_ror:1 row_mask:0xf bank_mask:0xf
  v_mfma_f32_16x16x32_bf16 v[172:175], v[116:119], v[124:127], v[172:175]
  s_waitcnt lgkmcnt(0)
  v_mfma_f32_16x16x32_bf16 v[184:187], v[88:91], v[88:91], v[184:187]
  ds_read_b64_tr_b16 v[120:121], v60 offset:8192
  ds_read_b64_tr_b16 v[122:123], v60 offset:12288
  v_mfma_f32_16x16x32_bf16 v[176:179], v[192:195], v[88:91], v[176:179]
  ds_read_b64_tr_b16 v[124:125], v61 offset:8192
  ds_read_b64_tr_b16 v[126:127], v61 offset:12288
  v_mfma_f32_16x16x32_bf16 v[188:191], v[92:95], v[92:95], v[188:191]
  ds_read_b128 v[96:99], v62 offset:6144
  ds_read_b128 v[100:103], v62 offset:7168
  v_mfma_f32_16x16x32_bf16 v[180:183], v[192:195], v[92:95], v[180:183]
  ds_read_b128 v[104:107], v62 offset:8192
  ds_read_b128 v[108:111], v62 offset:9216
  v_mfma_f32_16x16x32_bf16 v[128:131], v[64:67], v[88:91], v[128:131]
  ds_read_b128 v[112:115], v62 offset:10240
  ds_read_b128 v[116:119], v62 offset:11264
  v_mfma_f32_16x16x32_bf16 v[132:135], v[64:67], v[92:95], v[132:135]
  v_add_f32_dpp v44, v44, v44 row_ror:1 row_mask:0xf bank_mask:0xf
  v_mfma_f32_16x16x32_bf16 v[136:139], v[68:71], v[88:91], v[136:139]
  v_add_f32_dpp v45, v45, v45 row_ror:1 row_mask:0xf bank_mask:0xf
  v_mfma_f32_16x16x32_bf16 v[140:143], v[68:71], v[92:95], v[140:143]
  v_mfma_f32_16x16x32_bf16 v[144:147], v[72:75], v[88:91], v[144:147]
  v_add_f32_dpp v46, v46, v46 row_ror:1 row_mask:0xf bank_mask:0xf
  v_mfma_f32_16x16x32_bf16 v[148:151], v[72:75], v[92:95], v[148:151]
  v_mfma_f32_16x16x32_bf16 v[152:155], v[76:79], v[88:91], v[152:155]
  v_add_f32_dpp v47, v47, v47 row_ror:1 row_mask:0xf bank_mask:0xf
  v_mfma_f32_16x16x32_bf16 v[156:159], v[76:79], v[92:95], v[156:159]
  v_mfma_f32_16x16x32_bf16 v[160:163], v[80:83], v[88:91], v[160:163]
  v_add_f32_dpp v48, v48, v48 row_ror:1 row_mask:0xf bank_mask:0xf
  v_mfma_f32_16x16x32_bf16 v[164:167], v[80:83], v[92:95], v[164:167]
  v_mfma_f32_16x16x32_bf16 v[168:171], v[84:87], v[88:91], v[168:171]
  v_add_f32_dpp v49, v49, v49 row_ror:1 row_mask:0xf bank_mask:0xf
  v_mfma_f32_16x16x32_bf16 v[172:175], v[84:87], v[92:95], v[172:175]
  s_waitcnt lgkmcnt(0)
  s_barrier
  v_add_u32 v60, 122880, v10
  v_add_u32 v61, 122880, v11
  v_add_u32 v62, 122880, v12
  v_mfma_f32_16x16x32_bf16 v[184:187], v[120:123], v[120:123], v[184:187]
  ds_read_b64_tr_b16 v[88:89], v60 offset:0
  ds_read_b64_tr_b16 v[90:91], v60 offset:4096
  v_mfma_f32_16x16x32_bf16 v[176:179], v[192:195], v[120:123], v[176:179]
  ds_read_b64_tr_b16 v[92:93], v61 offset:0
  ds_read_b64_tr_b16 v[94:95], v61 offset:4096
  v_mfma_f32_16x16x32_bf16 v[188:191], v[124:127], v[124:127], v[188:191]
  ds_read_b128 v[64:67], v62 offset:0
  ds_read_b128 v[68:71], v62 offset:1024
  v_mfma_f32_16x16x32_bf16 v[180:183], v[192:195], v[124:127], v[180:183]
  ds_read_b128 v[72:75], v62 offset:2048
  ds_read_b128 v[76:79], v62 offset:3072
  v_mfma_f32_16x16x32_bf16 v[128:131], v[96:99], v[120:123], v[128:131]
  ds_read_b128 v[80:83], v62 offset:4096
  ds_read_b128 v[84:87], v62 offset:5120
  v_mfma_f32_16x16x32_bf16 v[132:135], v[96:99], v[124:127], v[132:135]
  v_add_f32_dpp v50, v50, v50 row_ror:1 row_mask:0xf bank_mask:0xf
  v_mfma_f32_16x16x32_bf16 v[136:139], v[100:103], v[120:123], v[136:139]
  v_add_f32_dpp v51, v51, v51 row_ror:1 row_mask:0xf bank_mask:0xf
  v_mfma_f32_16x16x32_bf16 v[140:143], v[100:103], v[124:127], v[140:143]
  v_mfma_f32_16x16x32_bf16 v[144:147], v[104:107], v[120:123], v[144:147]
  v_add_f32_dpp v52, v52, v52 row_ror:1 row_mask:0xf bank_mask:0xf
  v_mfma_f32_16x16x32_bf16 v[148:151], v[104:107], v[124:127], v[148:151]
  v_mfma_f32_16x16x32_bf16 v[152:155], v[108:111], v[120:123], v[152:155]
  v_add_f32_dpp v53, v53, v53 row_ror:1 row_mask:0xf bank_mask:0xf
  v_mfma_f32_16x16x32_bf16 v[156:159], v[108:111], v[124:127], v[156:159]
  v_mfma_f32_16x16x32_bf16 v[160:163], v[112:115], v[120:123], v[160:163]
  v_add_f32_dpp v54, v54, v54 row_ror:1 row_mask:0xf bank_mask:0xf
  v_mfma_f32_16x16x32_bf16 v[164:167], v[112:115], v[124:127], v[164:167]
  v_mfma_f32_16x16x32_bf16 v[168:171], v[116:119], v[120:123], v[168:171]
  v_add_f32_dpp v55, v55, v55 row_ror:1 row_mask:0xf bank_mask:0xf
  v_mfma_f32_16x16x32_bf16 v[172:175], v[116:119], v[124:127], v[172:175]
  s_waitcnt lgkmcnt(0)
  v_mfma_f32_16x16x32_bf16 v[184:187], v[88:91], v[88:91], v[184:187]
  ds_read_b64_tr_b16 v[120:121], v60 offset:8192
  ds_read_b64_tr_b16 v[122:123], v60 offset:12288
  v_mfma_f32_16x16x32_bf16 v[176:179], v[192:195], v[88:91], v[176:179]
  ds_read_b64_tr_b16 v[124:125], v61 offset:8192
  ds_read_b64_tr_b16 v[126:127], v61 offset:12288
  v_mfma_f32_16x16x32_bf16 v[188:191], v[92:95], v[92:95], v[188:191]
  ds_read_b128 v[96:99], v62 offset:6144
  ds_read_b128 v[100:103], v62 offset:7168
  v_mfma_f32_16x16x32_bf16 v[180:183], v[192:195], v[92:95], v[180:183]
  ds_read_b128 v[104:107], v62 offset:8192
  ds_read_b128 v[108:111], v62 offset:9216
  v_mfma_f32_16x16x32_bf16 v[128:131], v[64:67], v[88:91], v[128:131]
  ds_read_b128 v[112:115], v62 offset:10240
  ds_read_b128 v[116:119], v62 offset:11264
  v_mfma_f32_16x16x32_bf16 v[132:135], v[64:67], v[92:95], v[132:135]
  v_mfma_f32_16x16x32_bf16 v[136:139], v[68:71], v[88:91], v[136:139]
  v_mfma_f32_16x16x32_bf16 v[140:143], v[68:71], v[92:95], v[140:143]
  v_mfma_f32_16x16x32_bf16 v[144:147], v[72:75], v[88:91], v[144:147]
  v_mfma_f32_16x16x32_bf16 v[148:151], v[72:75], v[92:95], v[148:151]
  v_mfma_f32_16x16x32_bf16 v[152:155], v[76:79], v[88:91], v[152:155]
  v_mfma_f32_16x16x32_bf16 v[156:159], v[76:79], v[92:95], v[156:159]
  v_mfma_f32_16x16x32_bf16 v[160:163], v[80:83], v[88:91], v[160:163]
  v_mfma_f32_16x16x32_bf16 v[164:167], v[80:83], v[92:95], v[164:167]
  v_mfma_f32_16x16x32_bf16 v[168:171], v[84:87], v[88:91], v[168:171]
  v_mfma_f32_16x16x32_bf16 v[172:175], v[84:87], v[92:95], v[172:175]
  s_waitcnt lgkmcnt(0)
  s_barrier
  s_mov_b32 s60, 0xbdd2d3e8
  s_mov_b32 s61, s60
  s_mov_b32 s62, 1.0
  s_mov_b32 s63, 1.0
  s_mov_b32 s39, 49152
  v_mfma_f32_16x16x32_bf16 v[184:187], v[120:123], v[120:123], v[184:187]
  v_lshlrev_b32 v64, 16, v20
  v_and_b32 v65, 0xffff0000, v20
  v_mfma_f32_16x16x32_bf16 v[176:179], v[192:195], v[120:123], v[176:179]
  v_lshlrev_b32 v66, 16, v21
  v_and_b32 v67, 0xffff0000, v21
  v_mfma_f32_16x16x32_bf16 v[188:191], v[124:127], v[124:127], v[188:191]
  v_lshlrev_b32 v68, 16, v22
  v_and_b32 v69, 0xffff0000, v22
  v_mfma_f32_16x16x32_bf16 v[180:183], v[192:195], v[124:127], v[180:183]
  v_lshlrev_b32 v70, 16, v23
  v_and_b32 v71, 0xffff0000, v23
  v_mfma_f32_16x16x32_bf16 v[128:131], v[96:99], v[120:123], v[128:131]
  v_cndmask_b32 v76, v184, v185, s[4:5]
  s_nop 0
  v_cndmask_b32 v79, v188, v189, s[4:5]
  v_cndmask_b32 v77, v186, v187, s[4:5]
  v_cndmask_b32 v2, v190, v191, s[4:5]
  v_cndmask_b32 v76, v76, v77, s[6:7]
  v_mfma_f32_16x16x32_bf16 v[132:135], v[96:99], v[124:127], v[132:135]
  v_cndmask_b32 v79, v79, v2, s[6:7]
  v_cndmask_b32 v76, 0, v76, s[8:9]
  v_cndmask_b32 v79, 0, v79, s[8:9]
  v_mov_b32 v77, v76
  v_mov_b32 v2, v79
  v_mfma_f32_16x16x32_bf16 v[136:139], v[100:103], v[120:123], v[136:139]
  v_permlane16_swap_b32 v77, v76
  v_permlane16_swap_b32 v2, v79
  v_add_f32 v76, v77, v76
  v_add_f32 v79, v2, v79
  v_mov_b32 v77, v76
  v_mfma_f32_16x16x32_bf16 v[140:143], v[100:103], v[124:127], v[140:143]
  v_mov_b32 v2, v79
  v_permlane32_swap_b32 v77, v76
  s_nop 0
  v_permlane32_swap_b32 v2, v79
  v_add_f32 v76, v77, v76
  v_add_f32 v79, v2, v79
  v_mfma_f32_16x16x32_bf16 v[144:147], v[104:107], v[120:123], v[144:147]
  v_mul_f32 v77, 0x3acccccd, v176
  v_mul_f32 v2, 0x3acccccd, v180
  v_mul_f32 v78, 0x3acccccd, v76
  v_mul_f32 v3, 0x3acccccd, v79
  v_fma_f32 v78, -v77, v77, v78
  v_mfma_f32_16x16x32_bf16 v[148:151], v[104:107], v[124:127], v[148:151]
  v_fma_f32 v3, -v2, v2, v3
  v_max_f32 v78, 0, v78
  v_max_f32 v3, 0, v3
  v_add_f32 v78, 0x3727c5ac, v78
  v_mfma_f32_16x16x32_bf16 v[152:155], v[108:111], v[120:123], v[152:155]
  v_add_f32 v3, 0x3727c5ac, v3
  v_rsq_f32 v78, v78
  v_rsq_f32 v3, v3
  v_mul_f32 v8, v77, v78
  v_mul_f32 v10, v2, v3
  v_mfma_f32_16x16x32_bf16 v[156:159], v[108:111], v[124:127], v[156:159]
  v_sub_f32 v8, 0, v8
  v_sub_f32 v10, 0, v10
  v_mov_b32 v9, v8
  v_mov_b32 v11, v10
  v_mov_b32 v12, v78
  v_mfma_f32_16x16x32_bf16 v[160:163], v[112:115], v[120:123], v[160:163]
  v_mov_b32 v14, v3
  v_mov_b32 v13, v78
  v_mov_b32 v15, v3
  v_lshlrev_b32 v72, 16, v24
  v_and_b32 v73, 0xffff0000, v24
  v_mfma_f32_16x16x32_bf16 v[164:167], v[112:115], v[124:127], v[164:167]
  v_lshlrev_b32 v74, 16, v25
  v_and_b32 v75, 0xffff0000, v25
  v_lshlrev_b32 v80, 16, v26
  v_and_b32 v81, 0xffff0000, v26
  v_lshlrev_b32 v82, 16, v27
  v_mfma_f32_16x16x32_bf16 v[168:171], v[116:119], v[120:123], v[168:171]
  v_and_b32 v83, 0xffff0000, v27
  v_lshlrev_b32 v84, 16, v28
  v_and_b32 v85, 0xffff0000, v28
  v_lshlrev_b32 v86, 16, v29
  v_and_b32 v87, 0xffff0000, v29
  v_mfma_f32_16x16x32_bf16 v[172:175], v[116:119], v[124:127], v[172:175]
  v_lshlrev_b32 v88, 16, v30
  v_and_b32 v89, 0xffff0000, v30
  v_lshlrev_b32 v90, 16, v31
  v_and_b32 v91, 0xffff0000, v31
  v_mov_b32 v104, 0xc0135761
  v_mov_b32 v105, 0xc0135761
  v_pk_fma_f32 v[96:97], v[32:33], v[8:9], v[64:65]
  v_pk_fma_f32 v[98:99], v[34:35], v[8:9], v[66:67]
  v_pk_fma_f32 v[100:101], v[36:37], v[8:9], v[68:69]
  v_pk_fma_f32 v[102:103], v[38:39], v[8:9], v[70:71]
  v_pk_fma_f32 v[128:129], v[128:129], v[12:13], v[96:97]
  v_pk_fma_f32 v[130:131], v[130:131], v[12:13], v[98:99]
  v_pk_fma_f32 v[136:137], v[136:137], v[12:13], v[100:101]
  v_pk_fma_f32 v[138:139], v[138:139], v[12:13], v[102:103]
  v_pk_mul_f32 v[96:97], v[128:129], v[128:129]
  v_pk_mul_f32 v[98:99], v[130:131], v[130:131]
  v_pk_mul_f32 v[100:101], v[136:137], v[136:137]
  v_pk_mul_f32 v[102:103], v[138:139], v[138:139]
  v_pk_fma_f32 v[96:97], v[96:97], s[60:61], v[104:105]
  v_pk_fma_f32 v[98:99], v[98:99], s[60:61], v[104:105]
  v_pk_fma_f32 v[100:101], v[100:101], s[60:61], v[104:105]
  v_pk_fma_f32 v[102:103], v[102:103], s[60:61], v[104:105]
  v_pk_mul_f32 v[96:97], v[96:97], v[128:129]
  v_pk_mul_f32 v[98:99], v[98:99], v[130:131]
  v_pk_mul_f32 v[100:101], v[100:101], v[136:137]
  v_pk_mul_f32 v[102:103], v[102:103], v[138:139]
  v_exp_f32 v96, v96
  v_exp_f32 v97, v97
  v_exp_f32 v98, v98
  v_exp_f32 v99, v99
  v_exp_f32 v100, v100
  v_exp_f32 v101, v101
  v_exp_f32 v102, v102
  v_exp_f32 v103, v103
  v_pk_add_f32 v[96:97], v[96:97], s[62:63]
  v_pk_add_f32 v[98:99], v[98:99], s[62:63]
  v_pk_add_f32 v[100:101], v[100:101], s[62:63]
  v_pk_add_f32 v[102:103], v[102:103], s[62:63]
  v_rcp_f32 v96, v96
  v_rcp_f32 v97, v97
  v_rcp_f32 v98, v98
  v_rcp_f32 v99, v99
  v_rcp_f32 v100, v100
  v_rcp_f32 v101, v101
  v_rcp_f32 v102, v102
  v_rcp_f32 v103, v103
  v_pk_mul_f32 v[96:97], v[96:97], v[128:129]
  v_pk_mul_f32 v[98:99], v[98:99], v[130:131]
  v_pk_mul_f32 v[100:101], v[100:101], v[136:137]
  v_pk_mul_f32 v[102:103], v[102:103], v[138:139]
  v_cvt_pk_bf16_f32 v128, v96, v97
  v_cvt_pk_bf16_f32 v129, v98, v99
  v_cvt_pk_bf16_f32 v130, v100, v101
  v_cvt_pk_bf16_f32 v131, v102, v103
  v_pk_fma_f32 v[96:97], v[40:41], v[8:9], v[72:73]
  v_pk_fma_f32 v[98:99], v[42:43], v[8:9], v[74:75]
  v_pk_fma_f32 v[100:101], v[44:45], v[8:9], v[80:81]
  v_pk_fma_f32 v[102:103], v[46:47], v[8:9], v[82:83]
  v_pk_fma_f32 v[144:145], v[144:145], v[12:13], v[96:97]
  v_pk_fma_f32 v[146:147], v[146:147], v[12:13], v[98:99]
  v_pk_fma_f32 v[152:153], v[152:153], v[12:13], v[100:101]
  v_pk_fma_f32 v[154:155], v[154:155], v[12:13], v[102:103]
  v_pk_mul_f32 v[96:97], v[144:145], v[144:145]
  v_pk_mul_f32 v[98:99], v[146:147], v[146:147]
  v_pk_mul_f32 v[100:101], v[152:153], v[152:153]
  v_pk_mul_f32 v[102:103], v[154:155], v[154:155]
  v_pk_fma_f32 v[96:97], v[96:97], s[60:61], v[104:105]
  v_pk_fma_f32 v[98:99], v[98:99], s[60:61], v[104:105]
  v_pk_fma_f32 v[100:101], v[100:101], s[60:61], v[104:105]
  v_pk_fma_f32 v[102:103], v[102:103], s[60:61], v[104:105]
  v_pk_mul_f32 v[96:97], v[96:97], v[144:145]
  v_pk_mul_f32 v[98:99], v[98:99], v[146:147]
  v_pk_mul_f32 v[100:101], v[100:101], v[152:153]
  v_pk_mul_f32 v[102:103], v[102:103], v[154:155]
  v_exp_f32 v96, v96
  v_exp_f32 v97, v97
  v_exp_f32 v98, v98
  v_exp_f32 v99, v99
  v_exp_f32 v100, v100
  v_exp_f32 v101, v101
  v_exp_f32 v102, v102
  v_exp_f32 v103, v103
  v_pk_add_f32 v[96:97], v[96:97], s[62:63]
  v_pk_add_f32 v[98:99], v[98:99], s[62:63]
  v_pk_add_f32 v[100:101], v[100:101], s[62:63]
  v_pk_add_f32 v[102:103], v[102:103], s[62:63]
  v_rcp_f32 v96, v96
  v_rcp_f32 v97, v97
  v_rcp_f32 v98, v98
  v_rcp_f32 v99, v99
  v_rcp_f32 v100, v100
  v_rcp_f32 v101, v101
  v_rcp_f32 v102, v102
  v_rcp_f32 v103, v103
  v_pk_mul_f32 v[96:97], v[96:97], v[144:145]
  v_pk_mul_f32 v[98:99], v[98:99], v[146:147]
  v_pk_mul_f32 v[100:101], v[100:101], v[152:153]
  v_pk_mul_f32 v[102:103], v[102:103], v[154:155]
  v_cvt_pk_bf16_f32 v144, v96, v97
  v_cvt_pk_bf16_f32 v145, v98, v99
  v_cvt_pk_bf16_f32 v146, v100, v101
  v_cvt_pk_bf16_f32 v147, v102, v103
  v_pk_fma_f32 v[96:97], v[48:49], v[8:9], v[84:85]
  v_pk_fma_f32 v[98:99], v[50:51], v[8:9], v[86:87]
  v_pk_fma_f32 v[100:101], v[52:53], v[8:9], v[88:89]
  v_pk_fma_f32 v[102:103], v[54:55], v[8:9], v[90:91]
  v_pk_fma_f32 v[160:161], v[160:161], v[12:13], v[96:97]
  v_pk_fma_f32 v[162:163], v[162:163], v[12:13], v[98:99]
  v_pk_fma_f32 v[168:169], v[168:169], v[12:13], v[100:101]
  v_pk_fma_f32 v[170:171], v[170:171], v[12:13], v[102:103]
  v_pk_mul_f32 v[96:97], v[160:161], v[160:161]
  v_pk_mul_f32 v[98:99], v[162:163], v[162:163]
  v_pk_mul_f32 v[100:101], v[168:169], v[168:169]
  v_pk_mul_f32 v[102:103], v[170:171], v[170:171]
  v_pk_fma_f32 v[96:97], v[96:97], s[60:61], v[104:105]
  v_pk_fma_f32 v[98:99], v[98:99], s[60:61], v[104:105]
  v_pk_fma_f32 v[100:101], v[100:101], s[60:61], v[104:105]
  v_pk_fma_f32 v[102:103], v[102:103], s[60:61], v[104:105]
  v_pk_mul_f32 v[96:97], v[96:97], v[160:161]
  v_pk_mul_f32 v[98:99], v[98:99], v[162:163]
  v_pk_mul_f32 v[100:101], v[100:101], v[168:169]
  v_pk_mul_f32 v[102:103], v[102:103], v[170:171]
  v_exp_f32 v96, v96
  v_exp_f32 v97, v97
  v_exp_f32 v98, v98
  v_exp_f32 v99, v99
  v_exp_f32 v100, v100
  v_exp_f32 v101, v101
  v_exp_f32 v102, v102
  v_exp_f32 v103, v103
  v_pk_add_f32 v[96:97], v[96:97], s[62:63]
  v_pk_add_f32 v[98:99], v[98:99], s[62:63]
  v_pk_add_f32 v[100:101], v[100:101], s[62:63]
  v_pk_add_f32 v[102:103], v[102:103], s[62:63]
  v_rcp_f32 v96, v96
  v_rcp_f32 v97, v97
  v_rcp_f32 v98, v98
  v_rcp_f32 v99, v99
  v_rcp_f32 v100, v100
  v_rcp_f32 v101, v101
  v_rcp_f32 v102, v102
  v_rcp_f32 v103, v103
  v_pk_mul_f32 v[96:97], v[96:97], v[160:161]
  v_pk_mul_f32 v[98:99], v[98:99], v[162:163]
  v_pk_mul_f32 v[100:101], v[100:101], v[168:169]
  v_pk_mul_f32 v[102:103], v[102:103], v[170:171]
  v_cvt_pk_bf16_f32 v160, v96, v97
  v_cvt_pk_bf16_f32 v161, v98, v99
  v_cvt_pk_bf16_f32 v162, v100, v101
  v_cvt_pk_bf16_f32 v163, v102, v103
  v_pk_fma_f32 v[96:97], v[32:33], v[10:11], v[64:65]
  v_pk_fma_f32 v[98:99], v[34:35], v[10:11], v[66:67]
  v_pk_fma_f32 v[100:101], v[36:37], v[10:11], v[68:69]
  v_pk_fma_f32 v[102:103], v[38:39], v[10:11], v[70:71]
  v_pk_fma_f32 v[132:133], v[132:133], v[14:15], v[96:97]
  v_pk_fma_f32 v[134:135], v[134:135], v[14:15], v[98:99]
  v_pk_fma_f32 v[140:141], v[140:141], v[14:15], v[100:101]
  v_pk_fma_f32 v[142:143], v[142:143], v[14:15], v[102:103]
  v_pk_mul_f32 v[96:97], v[132:133], v[132:133]
  v_pk_mul_f32 v[98:99], v[134:135], v[134:135]
  v_pk_mul_f32 v[100:101], v[140:141], v[140:141]
  v_pk_mul_f32 v[102:103], v[142:143], v[142:143]
  v_pk_fma_f32 v[96:97], v[96:97], s[60:61], v[104:105]
  v_pk_fma_f32 v[98:99], v[98:99], s[60:61], v[104:105]
  v_pk_fma_f32 v[100:101], v[100:101], s[60:61], v[104:105]
  v_pk_fma_f32 v[102:103], v[102:103], s[60:61], v[104:105]
  v_pk_mul_f32 v[96:97], v[96:97], v[132:133]
  v_pk_mul_f32 v[98:99], v[98:99], v[134:135]
  v_pk_mul_f32 v[100:101], v[100:101], v[140:141]
  v_pk_mul_f32 v[102:103], v[102:103], v[142:143]
  v_exp_f32 v96, v96
  v_exp_f32 v97, v97
  v_exp_f32 v98, v98
  v_exp_f32 v99, v99
  v_exp_f32 v100, v100
  v_exp_f32 v101, v101
  v_exp_f32 v102, v102
  v_exp_f32 v103, v103
  v_pk_add_f32 v[96:97], v[96:97], s[62:63]
  v_pk_add_f32 v[98:99], v[98:99], s[62:63]
  v_pk_add_f32 v[100:101], v[100:101], s[62:63]
  v_pk_add_f32 v[102:103], v[102:103], s[62:63]
  v_rcp_f32 v96, v96
  v_rcp_f32 v97, v97
  v_rcp_f32 v98, v98
  v_rcp_f32 v99, v99
  v_rcp_f32 v100, v100
  v_rcp_f32 v101, v101
  v_rcp_f32 v102, v102
  v_rcp_f32 v103, v103
  v_pk_mul_f32 v[96:97], v[96:97], v[132:133]
  v_pk_mul_f32 v[98:99], v[98:99], v[134:135]
  v_pk_mul_f32 v[100:101], v[100:101], v[140:141]
  v_pk_mul_f32 v[102:103], v[102:103], v[142:143]
  v_cvt_pk_bf16_f32 v132, v96, v97
  v_cvt_pk_bf16_f32 v133, v98, v99
  v_cvt_pk_bf16_f32 v134, v100, v101
  v_cvt_pk_bf16_f32 v135, v102, v103
  v_pk_fma_f32 v[96:97], v[40:41], v[10:11], v[72:73]
  v_pk_fma_f32 v[98:99], v[42:43], v[10:11], v[74:75]
  v_pk_fma_f32 v[100:101], v[44:45], v[10:11], v[80:81]
  v_pk_fma_f32 v[102:103], v[46:47], v[10:11], v[82:83]
  v_pk_fma_f32 v[148:149], v[148:149], v[14:15], v[96:97]
  v_pk_fma_f32 v[150:151], v[150:151], v[14:15], v[98:99]
  v_pk_fma_f32 v[156:157], v[156:157], v[14:15], v[100:101]
  v_pk_fma_f32 v[158:159], v[158:159], v[14:15], v[102:103]
  v_pk_mul_f32 v[96:97], v[148:149], v[148:149]
  v_pk_mul_f32 v[98:99], v[150:151], v[150:151]
  v_pk_mul_f32 v[100:101], v[156:157], v[156:157]
  v_pk_mul_f32 v[102:103], v[158:159], v[158:159]
  v_pk_fma_f32 v[96:97], v[96:97], s[60:61], v[104:105]
  v_pk_fma_f32 v[98:99], v[98:99], s[60:61], v[104:105]
  v_pk_fma_f32 v[100:101], v[100:101], s[60:61], v[104:105]
  v_pk_fma_f32 v[102:103], v[102:103], s[60:61], v[104:105]
  v_pk_mul_f32 v[96:97], v[96:97], v[148:149]
  v_pk_mul_f32 v[98:99], v[98:99], v[150:151]
  v_pk_mul_f32 v[100:101], v[100:101], v[156:157]
  v_pk_mul_f32 v[102:103], v[102:103], v[158:159]
  v_exp_f32 v96, v96
  v_exp_f32 v97, v97
  v_exp_f32 v98, v98
  v_exp_f32 v99, v99
  v_exp_f32 v100, v100
  v_exp_f32 v101, v101
  v_exp_f32 v102, v102
  v_exp_f32 v103, v103
  v_pk_add_f32 v[96:97], v[96:97], s[62:63]
  v_pk_add_f32 v[98:99], v[98:99], s[62:63]
  v_pk_add_f32 v[100:101], v[100:101], s[62:63]
  v_pk_add_f32 v[102:103], v[102:103], s[62:63]
  v_rcp_f32 v96, v96
  v_rcp_f32 v97, v97
  v_rcp_f32 v98, v98
  v_rcp_f32 v99, v99
  v_rcp_f32 v100, v100
  v_rcp_f32 v101, v101
  v_rcp_f32 v102, v102
  v_rcp_f32 v103, v103
  v_pk_mul_f32 v[96:97], v[96:97], v[148:149]
  v_pk_mul_f32 v[98:99], v[98:99], v[150:151]
  v_pk_mul_f32 v[100:101], v[100:101], v[156:157]
  v_pk_mul_f32 v[102:103], v[102:103], v[158:159]
  v_cvt_pk_bf16_f32 v148, v96, v97
  v_cvt_pk_bf16_f32 v149, v98, v99
  v_cvt_pk_bf16_f32 v150, v100, v101
  v_cvt_pk_bf16_f32 v151, v102, v103
  v_pk_fma_f32 v[96:97], v[48:49], v[10:11], v[84:85]
  v_pk_fma_f32 v[98:99], v[50:51], v[10:11], v[86:87]
  v_pk_fma_f32 v[100:101], v[52:53], v[10:11], v[88:89]
  v_pk_fma_f32 v[102:103], v[54:55], v[10:11], v[90:91]
  v_pk_fma_f32 v[164:165], v[164:165], v[14:15], v[96:97]
  v_pk_fma_f32 v[166:167], v[166:167], v[14:15], v[98:99]
  v_pk_fma_f32 v[172:173], v[172:173], v[14:15], v[100:101]
  v_pk_fma_f32 v[174:175], v[174:175], v[14:15], v[102:103]
  v_pk_mul_f32 v[96:97], v[164:165], v[164:165]
  v_pk_mul_f32 v[98:99], v[166:167], v[166:167]
  v_pk_mul_f32 v[100:101], v[172:173], v[172:173]
  v_pk_mul_f32 v[102:103], v[174:175], v[174:175]
  v_pk_fma_f32 v[96:97], v[96:97], s[60:61], v[104:105]
  v_pk_fma_f32 v[98:99], v[98:99], s[60:61], v[104:105]
  v_pk_fma_f32 v[100:101], v[100:101], s[60:61], v[104:105]
  v_pk_fma_f32 v[102:103], v[102:103], s[60:61], v[104:105]
  v_pk_mul_f32 v[96:97], v[96:97], v[164:165]
  v_pk_mul_f32 v[98:99], v[98:99], v[166:167]
  v_pk_mul_f32 v[100:101], v[100:101], v[172:173]
  v_pk_mul_f32 v[102:103], v[102:103], v[174:175]
  v_exp_f32 v96, v96
  v_exp_f32 v97, v97
  v_exp_f32 v98, v98
  v_exp_f32 v99, v99
  v_exp_f32 v100, v100
  v_exp_f32 v101, v101
  v_exp_f32 v102, v102
  v_exp_f32 v103, v103
  v_pk_add_f32 v[96:97], v[96:97], s[62:63]
  v_pk_add_f32 v[98:99], v[98:99], s[62:63]
  v_pk_add_f32 v[100:101], v[100:101], s[62:63]
  v_pk_add_f32 v[102:103], v[102:103], s[62:63]
  v_rcp_f32 v96, v96
  v_rcp_f32 v97, v97
  v_rcp_f32 v98, v98
  v_rcp_f32 v99, v99
  v_rcp_f32 v100, v100
  v_rcp_f32 v101, v101
  v_rcp_f32 v102, v102
  v_rcp_f32 v103, v103
  v_pk_mul_f32 v[96:97], v[96:97], v[164:165]
  v_pk_mul_f32 v[98:99], v[98:99], v[166:167]
  v_pk_mul_f32 v[100:101], v[100:101], v[172:173]
  v_pk_mul_f32 v[102:103], v[102:103], v[174:175]
  v_cvt_pk_bf16_f32 v164, v96, v97
  v_cvt_pk_bf16_f32 v165, v98, v99
  v_cvt_pk_bf16_f32 v166, v100, v101
  v_cvt_pk_bf16_f32 v167, v102, v103
  buffer_store_dwordx4 v[128:131], v17, s[28:31], 0 offen offset:0 sc1
  buffer_store_dwordx4 v[144:147], v17, s[28:31], 0 offen offset:1024 sc1
  buffer_store_dwordx4 v[160:163], v17, s[28:31], 0 offen offset:2048 sc1
  buffer_store_dwordx4 v[132:135], v17, s[28:31], s39 offen offset:0 sc1
  buffer_store_dwordx4 v[148:151], v17, s[28:31], s39 offen offset:1024 sc1
  buffer_store_dwordx4 v[164:167], v17, s[28:31], s39 offen offset:2048 sc1
  s_waitcnt vmcnt(0)
  v_mov_b32 v9, 153600
  v_mov_b32 v8, 1
  s_mov_b64 exec, 1
  ds_add_u32 v9, v8
  s_mov_b64 exec, -1
  s_cmp_eq_u32 s33, 0
  s_cbranch_scc0 KB_NOPOLL
  s_mov_b32 s60, 0
KB_CNT:
  ds_read_b32 v8, v9
  s_waitcnt lgkmcnt(0)
  v_readfirstlane_b32 s61, v8
  s_add_u32 s60, s60, 1
  s_cmp_ge_u32 s60, 200000
  s_cbranch_scc1 KB_CNTX
  s_cmp_lt_u32 s61, 4
  s_cbranch_scc1 KB_CNT
KB_CNTX:
  s_lshl_b32 s60, s34, 11
  s_lshl_b32 s61, s35, 7
  s_add_u32 s61, s61, s60
  v_mov_b32 v8, s61
  v_mov_b32 v9, s32
  v_lshlrev_b32 v64, 7, v1
  v_add_u32 v64, s60, v64
  s_mov_b64 exec, 1
  buffer_store_dword v9, v8, s[56:59], 0 offen sc1
  s_mov_b64 exec, 0xffff
  s_mov_b32 s60, 0
  s_sleep 20
KB_POLL:
  buffer_load_dword v65, v64, s[56:59], 0 offen sc1
  s_waitcnt vmcnt(0)
  v_cmp_ne_u32 vcc, s32, v65
  s_add_u32 s60, s60, 1
  s_cmp_ge_u32 s60, 200000
  s_cbranch_scc1 KB_POLLX
  s_cbranch_vccz KB_POLLX
  s_sleep 6
  s_branch KB_POLL
KB_POLLX:
  s_mov_b64 exec, -1
KB_NOPOLL:
  s_waitcnt lgkmcnt(0)
  s_barrier
  s_mov_b32 s61, 49152
  v_add_u32 v57, s61, v56
  s_mov_b32 s60, 0
  buffer_load_dwordx4 a[0:3], v56, s[28:31], s60 offen offset:0 sc1
  s_mov_b32 s60, 0
  buffer_load_dwordx4 a[4:7], v57, s[28:31], s60 offen offset:0 sc1
  s_mov_b32 s60, 0
  buffer_load_dwordx4 a[8:11], v56, s[28:31], s60 offen offset:2048 sc1
  s_mov_b32 s60, 0
  buffer_load_dwordx4 a[12:15], v57, s[28:31], s60 offen offset:2048 sc1
  s_mov_b32 s60, 4096
  buffer_load_dwordx4 a[16:19], v56, s[28:31], s60 offen offset:0 sc1
  s_mov_b32 s60, 4096
  buffer_load_dwordx4 a[20:23], v57, s[28:31], s60 offen offset:0 sc1
  s_mov_b32 s60, 4096
  buffer_load_dwordx4 a[24:27], v56, s[28:31], s60 offen offset:2048 sc1
  s_mov_b32 s60, 4096
  buffer_load_dwordx4 a[28:31], v57, s[28:31], s60 offen offset:2048 sc1
  s_mov_b32 s60, 8192
  buffer_load_dwordx4 a[32:35], v56, s[28:31], s60 offen offset:0 sc1
  s_mov_b32 s60, 8192
  buffer_load_dwordx4 a[36:39], v57, s[28:31], s60 offen offset:0 sc1
  s_mov_b32 s60, 8192
  buffer_load_dwordx4 a[40:43], v56, s[28:31], s60 offen offset:2048 sc1
  s_mov_b32 s60, 8192
  buffer_load_dwordx4 a[44:47], v57, s[28:31], s60 offen offset:2048 sc1
  s_lshr_b32 s62, s33, 1
  s_mul_i32 s62, s62, 5120
  v_add_u32 v18, s62, v18
  v_mov_b32 v60, v18
  ds_read_b128 v[64:67], v60 offset:0
  ds_read_b128 v[68:71], v60 offset:1024
  ds_read_b128 v[72:75], v60 offset:2048
  ds_read_b128 v[76:79], v60 offset:3072
  ds_read_b128 v[80:83], v60 offset:4096
  s_waitcnt lgkmcnt(0)
  s_waitcnt vmcnt(11)
  v_mfma_f32_16x16x32_bf16 v[104:107], v[64:67], a[0:3], 0
  ds_read_b128 v[84:87], v60 offset:10240
  s_waitcnt vmcnt(10)
  v_mfma_f32_16x16x32_bf16 v[124:127], v[64:67], a[4:7], 0
  ds_read_b128 v[88:91], v60 offset:11264
  v_mfma_f32_16x16x32_bf16 v[108:111], v[68:71], a[0:3], 0
  ds_read_b128 v[92:95], v60 offset:12288
  v_mfma_f32_16x16x32_bf16 v[128:131], v[68:71], a[4:7], 0
  ds_read_b128 v[96:99], v60 offset:13312
  v_mfma_f32_16x16x32_bf16 v[112:115], v[72:75], a[0:3], 0
  ds_read_b128 v[100:103], v60 offset:14336
  v_mfma_f32_16x16x32_bf16 v[132:135], v[72:75], a[4:7], 0
  s_mov_b32 s60, 12288
  buffer_load_dwordx4 a[48:51], v56, s[28:31], s60 offen offset:0 sc1
  v_mfma_f32_16x16x32_bf16 v[116:119], v[76:79], a[0:3], 0
  v_mfma_f32_16x16x32_bf16 v[136:139], v[76:79], a[4:7], 0
  s_mov_b32 s60, 12288
  buffer_load_dwordx4 a[52:55], v57, s[28:31], s60 offen offset:0 sc1
  v_mfma_f32_16x16x32_bf16 v[120:123], v[80:83], a[0:3], 0
  v_mfma_f32_16x16x32_bf16 v[140:143], v[80:83], a[4:7], 0
  s_waitcnt lgkmcnt(0)
  s_waitcnt vmcnt(11)
  v_mfma_f32_16x16x32_bf16 v[104:107], v[84:87], a[8:11], v[104:107]
  ds_read_b128 v[64:67], v60 offset:20480
  s_waitcnt vmcnt(10)
  v_mfma_f32_16x16x32_bf16 v[124:127], v[84:87], a[12:15], v[124:127]
  ds_read_b128 v[68:71], v60 offset:21504
  v_mfma_f32_16x16x32_bf16 v[108:111], v[88:91], a[8:11], v[108:111]
  ds_read_b128 v[72:75], v60 offset:22528
  v_mfma_f32_16x16x32_bf16 v[128:131], v[88:91], a[12:15], v[128:131]
  ds_read_b128 v[76:79], v60 offset:23552
  v_mfma_f32_16x16x32_bf16 v[112:115], v[92:95], a[8:11], v[112:115]
  ds_read_b128 v[80:83], v60 offset:24576
  v_mfma_f32_16x16x32_bf16 v[132:135], v[92:95], a[12:15], v[132:135]
  s_mov_b32 s60, 12288
  buffer_load_dwordx4 a[56:59], v56, s[28:31], s60 offen offset:2048 sc1
  v_mfma_f32_16x16x32_bf16 v[116:119], v[96:99], a[8:11], v[116:119]
  v_mfma_f32_16x16x32_bf16 v[136:139], v[96:99], a[12:15], v[136:139]
  s_mov_b32 s60, 12288
  buffer_load_dwordx4 v[144:147], v57, s[28:31], s60 offen offset:2048 sc1
  v_mfma_f32_16x16x32_bf16 v[120:123], v[100:103], a[8:11], v[120:123]
  v_mfma_f32_16x16x32_bf16 v[140:143], v[100:103], a[12:15], v[140:143]
  s_waitcnt lgkmcnt(0)
  s_barrier
  v_add_u32 v60, 30720, v18
  s_waitcnt vmcnt(11)
  v_mfma_f32_16x16x32_bf16 v[104:107], v[64:67], a[16:19], v[104:107]
  ds_read_b128 v[84:87], v60 offset:0
  s_waitcnt vmcnt(10)
  v_mfma_f32_16x16x32_bf16 v[124:127], v[64:67], a[20:23], v[124:127]
  ds_read_b128 v[88:91], v60 offset:1024
  v_mfma_f32_16x16x32_bf16 v[108:111], v[68:71], a[16:19], v[108:111]
  ds_read_b128 v[92:95], v60 offset:2048
  v_mfma_f32_16x16x32_bf16 v[128:131], v[68:71], a[20:23], v[128:131]
  ds_read_b128 v[96:99], v60 offset:3072
  v_mfma_f32_16x16x32_bf16 v[112:115], v[72:75], a[16:19], v[112:115]
  ds_read_b128 v[100:103], v60 offset:4096
  v_mfma_f32_16x16x32_bf16 v[132:135], v[72:75], a[20:23], v[132:135]
  s_mov_b32 s60, 16384
  buffer_load_dwordx4 v[148:151], v56, s[28:31], s60 offen offset:0 sc1
  v_mfma_f32_16x16x32_bf16 v[116:119], v[76:79], a[16:19], v[116:119]
  v_mfma_f32_16x16x32_bf16 v[136:139], v[76:79], a[20:23], v[136:139]
  s_mov_b32 s60, 16384
  buffer_load_dwordx4 v[152:155], v57, s[28:31], s60 offen offset:0 sc1
  v_mfma_f32_16x16x32_bf16 v[120:123], v[80:83], a[16:19], v[120:123]
  v_mfma_f32_16x16x32_bf16 v[140:143], v[80:83], a[20:23], v[140:143]
  s_waitcnt lgkmcnt(0)
  s_waitcnt vmcnt(11)
  v_mfma_f32_16x16x32_bf16 v[104:107], v[84:87], a[24:27], v[104:107]
  ds_read_b128 v[64:67], v60 offset:10240
  s_waitcnt vmcnt(10)
  v_mfma_f32_16x16x32_bf16 v[124:127], v[84:87], a[28:31], v[124:127]
  ds_read_b128 v[68:71], v60 offset:11264
  v_mfma_f32_16x16x32_bf16 v[108:111], v[88:91], a[24:27], v[108:111]
  ds_read_b128 v[72:75], v60 offset:12288
  v_mfma_f32_16x16x32_bf16 v[128:131], v[88:91], a[28:31], v[128:131]
  ds_read_b128 v[76:79], v60 offset:13312
  v_mfma_f32_16x16x32_bf16 v[112:115], v[92:95], a[24:27], v[112:115]
  ds_read_b128 v[80:83], v60 offset:14336
  v_mfma_f32_16x16x32_bf16 v[132:135], v[92:95], a[28:31], v[132:135]
  s_mov_b32 s60, 16384
  buffer_load_dwordx4 v[156:159], v56, s[28:31], s60 offen offset:2048 sc1
  v_mfma_f32_16x16x32_bf16 v[116:119], v[96:99], a[24:27], v[116:119]
  v_mfma_f32_16x16x32_bf16 v[136:139], v[96:99], a[28:31], v[136:139]
  s_mov_b32 s60, 16384
  buffer_load_dwordx4 v[160:163], v57, s[28:31], s60 offen offset:2048 sc1
  v_mfma_f32_16x16x32_bf16 v[120:123], v[100:103], a[24:27], v[120:123]
  v_mfma_f32_16x16x32_bf16 v[140:143], v[100:103], a[28:31], v[140:143]
  s_waitcnt lgkmcnt(0)
  s_waitcnt vmcnt(11)
  v_mfma_f32_16x16x32_bf16 v[104:107], v[64:67], a[32:35], v[104:107]
  ds_read_b128 v[84:87], v60 offset:20480
  s_waitcnt vmcnt(10)
  v_mfma_f32_16x16x32_bf16 v[124:127], v[64:67], a[36:39], v[124:127]
  ds_read_b128 v[88:91], v60 offset:21504
  v_mfma_f32_16x16x32_bf16 v[108:111], v[68:71], a[32:35], v[108:111]
  ds_read_b128 v[92:95], v60 offset:22528
  v_mfma_f32_16x16x32_bf16 v[128:131], v[68:71], a[36:39], v[128:131]
  ds_read_b128 v[96:99], v60 offset:23552
  v_mfma_f32_16x16x32_bf16 v[112:115], v[72:75], a[32:35], v[112:115]
  ds_read_b128 v[100:103], v60 offset:24576
  v_mfma_f32_16x16x32_bf16 v[132:135], v[72:75], a[36:39], v[132:135]
  s_mov_b32 s60, 20480
  buffer_load_dwordx4 v[164:167], v56, s[28:31], s60 offen offset:0 sc1
  v_mfma_f32_16x16x32_bf16 v[116:119], v[76:79], a[32:35], v[116:119]
  v_mfma_f32_16x16x32_bf16 v[136:139], v[76:79], a[36:39], v[136:139]
  s_mov_b32 s60, 20480
  buffer_load_dwordx4 v[168:171], v57, s[28:31], s60 offen offset:0 sc1
  v_mfma_f32_16x16x32_bf16 v[120:123], v[80:83], a[32:35], v[120:123]
  v_mfma_f32_16x16x32_bf16 v[140:143], v[80:83], a[36:39], v[140:143]
  s_waitcnt lgkmcnt(0)
  s_barrier
  v_add_u32 v60, 61440, v18
  s_waitcnt vmcnt(11)
  v_mfma_f32_16x16x32_bf16 v[104:107], v[84:87], a[40:43], v[104:107]
  ds_read_b128 v[64:67], v60 offset:0
  s_waitcnt vmcnt(10)
  v_mfma_f32_16x16x32_bf16 v[124:127], v[84:87], a[44:47], v[124:127]
  ds_read_b128 v[68:71], v60 offset:1024
  v_mfma_f32_16x16x32_bf16 v[108:111], v[88:91], a[40:43], v[108:111]
  ds_read_b128 v[72:75], v60 offset:2048
  v_mfma_f32_16x16x32_bf16 v[128:131], v[88:91], a[44:47], v[128:131]
  ds_read_b128 v[76:79], v60 offset:3072
  v_mfma_f32_16x16x32_bf16 v[112:115], v[92:95], a[40:43], v[112:115]
  ds_read_b128 v[80:83], v60 offset:4096
  v_mfma_f32_16x16x32_bf16 v[132:135], v[92:95], a[44:47], v[132:135]
  s_mov_b32 s60, 20480
  buffer_load_dwordx4 v[172:175], v56, s[28:31], s60 offen offset:2048 sc1
  v_mfma_f32_16x16x32_bf16 v[116:119], v[96:99], a[40:43], v[116:119]
  v_mfma_f32_16x16x32_bf16 v[136:139], v[96:99], a[44:47], v[136:139]
  s_mov_b32 s60, 20480
  buffer_load_dwordx4 v[176:179], v57, s[28:31], s60 offen offset:2048 sc1
  v_mfma_f32_16x16x32_bf16 v[120:123], v[100:103], a[40:43], v[120:123]
  v_mfma_f32_16x16x32_bf16 v[140:143], v[100:103], a[44:47], v[140:143]
  s_waitcnt lgkmcnt(0)
  s_waitcnt vmcnt(11)
  v_mfma_f32_16x16x32_bf16 v[104:107], v[64:67], a[48:51], v[104:107]
  ds_read_b128 v[84:87], v60 offset:10240
  s_waitcnt vmcnt(10)
  v_mfma_f32_16x16x32_bf16 v[124:127], v[64:67], a[52:55], v[124:127]
  ds_read_b128 v[88:91], v60 offset:11264
  v_mfma_f32_16x16x32_bf16 v[108:111], v[68:71], a[48:51], v[108:111]
  ds_read_b128 v[92:95], v60 offset:12288
  v_mfma_f32_16x16x32_bf16 v[128:131], v[68:71], a[52:55], v[128:131]
  ds_read_b128 v[96:99], v60 offset:13312
  v_mfma_f32_16x16x32_bf16 v[112:115], v[72:75], a[48:51], v[112:115]
  ds_read_b128 v[100:103], v60 offset:14336
  v_mfma_f32_16x16x32_bf16 v[132:135], v[72:75], a[52:55], v[132:135]
  s_mov_b32 s60, 24576
  buffer_load_dwordx4 v[180:183], v56, s[28:31], s60 offen offset:0 sc1
  v_mfma_f32_16x16x32_bf16 v[116:119], v[76:79], a[48:51], v[116:119]
  v_mfma_f32_16x16x32_bf16 v[136:139], v[76:79], a[52:55], v[136:139]
  s_mov_b32 s60, 24576
  buffer_load_dwordx4 v[184:187], v57, s[28:31], s60 offen offset:0 sc1
  v_mfma_f32_16x16x32_bf16 v[120:123], v[80:83], a[48:51], v[120:123]
  v_mfma_f32_16x16x32_bf16 v[140:143], v[80:83], a[52:55], v[140:143]
  s_waitcnt lgkmcnt(0)
  s_waitcnt vmcnt(11)
  v_mfma_f32_16x16x32_bf16 v[104:107], v[84:87], a[56:59], v[104:107]
  ds_read_b128 v[64:67], v60 offset:20480
  s_waitcnt vmcnt(10)
  v_mfma_f32_16x16x32_bf16 v[124:127], v[84:87], v[144:147], v[124:127]
  ds_read_b128 v[68:71], v60 offset:21504
  v_mfma_f32_16x16x32_bf16 v[108:111], v[88:91], a[56:59], v[108:111]
  ds_read_b128 v[72:75], v60 offset:22528
  v_mfma_f32_16x16x32_bf16 v[128:131], v[88:91], v[144:147], v[128:131]
  ds_read_b128 v[76:79], v60 offset:23552
  v_mfma_f32_16x16x32_bf16 v[112:115], v[92:95], a[56:59], v[112:115]
  ds_read_b128 v[80:83], v60 offset:24576
  v_mfma_f32_16x16x32_bf16 v[132:135], v[92:95], v[144:147], v[132:135]
  s_mov_b32 s60, 24576
  buffer_load_dwordx4 v[188:191], v56, s[28:31], s60 offen offset:2048 sc1
  v_mfma_f32_16x16x32_bf16 v[116:119], v[96:99], a[56:59], v[116:119]
  v_mfma_f32_16x16x32_bf16 v[136:139], v[96:99], v[144:147], v[136:139]
  s_mov_b32 s60, 24576
  buffer_load_dwordx4 v[192:195], v57, s[28:31], s60 offen offset:2048 sc1
  v_mfma_f32_16x16x32_bf16 v[120:123], v[100:103], a[56:59], v[120:123]
  v_mfma_f32_16x16x32_bf16 v[140:143], v[100:103], v[144:147], v[140:143]
  s_waitcnt lgkmcnt(0)
  s_barrier
  v_add_u32 v60, 92160, v18
  s_waitcnt vmcnt(11)
  v_mfma_f32_16x16x32_bf16 v[104:107], v[64:67], v[148:151], v[104:107]
  ds_read_b128 v[84:87], v60 offset:0
  s_waitcnt vmcnt(10)
  v_mfma_f32_16x16x32_bf16 v[124:127], v[64:67], v[152:155], v[124:127]
  ds_read_b128 v[88:91], v60 offset:1024
  v_mfma_f32_16x16x32_bf16 v[108:111], v[68:71], v[148:151], v[108:111]
  ds_read_b128 v[92:95], v60 offset:2048
  v_mfma_f32_16x16x32_bf16 v[128:131], v[68:71], v[152:155], v[128:131]
  ds_read_b128 v[96:99], v60 offset:3072
  v_mfma_f32_16x16x32_bf16 v[112:115], v[72:75], v[148:151], v[112:115]
  ds_read_b128 v[100:103], v60 offset:4096
  v_mfma_f32_16x16x32_bf16 v[132:135], v[72:75], v[152:155], v[132:135]
  s_mov_b32 s60, 28672
  buffer_load_dwordx4 a[0:3], v56, s[28:31], s60 offen offset:0 sc1
  v_mfma_f32_16x16x32_bf16 v[116:119], v[76:79], v[148:151], v[116:119]
  v_mfma_f32_16x16x32_bf16 v[136:139], v[76:79], v[152:155], v[136:139]
  s_mov_b32 s60, 28672
  buffer_load_dwordx4 a[4:7], v57, s[28:31], s60 offen offset:0 sc1
  v_mfma_f32_16x16x32_bf16 v[120:123], v[80:83], v[148:151], v[120:123]
  v_mfma_f32_16x16x32_bf16 v[140:143], v[80:83], v[152:155], v[140:143]
  s_waitcnt lgkmcnt(0)
  s_waitcnt vmcnt(11)
  v_mfma_f32_16x16x32_bf16 v[104:107], v[84:87], v[156:159], v[104:107]
  ds_read_b128 v[64:67], v60 offset:10240
  s_waitcnt vmcnt(10)
  v_mfma_f32_16x16x32_bf16 v[124:127], v[84:87], v[160:163], v[124:127]
  ds_read_b128 v[68:71], v60 offset:11264
  v_mfma_f32_16x16x32_bf16 v[108:111], v[88:91], v[156:159], v[108:111]
  ds_read_b128 v[72:75], v60 offset:12288
  v_mfma_f32_16x16x32_bf16 v[128:131], v[88:91], v[160:163], v[128:131]
  ds_read_b128 v[76:79], v60 offset:13312
  v_mfma_f32_16x16x32_bf16 v[112:115], v[92:95], v[156:159], v[112:115]
  ds_read_b128 v[80:83], v60 offset:14336
  v_mfma_f32_16x16x32_bf16 v[132:135], v[92:95], v[160:163], v[132:135]
  s_mov_b32 s60, 28672
  buffer_load_dwordx4 a[8:11], v56, s[28:31], s60 offen offset:2048 sc1
  v_mfma_f32_16x16x32_bf16 v[116:119], v[96:99], v[156:159], v[116:119]
  v_mfma_f32_16x16x32_bf16 v[136:139], v[96:99], v[160:163], v[136:139]
  s_mov_b32 s60, 28672
  buffer_load_dwordx4 a[12:15], v57, s[28:31], s60 offen offset:2048 sc1
  v_mfma_f32_16x16x32_bf16 v[120:123], v[100:103], v[156:159], v[120:123]
  v_mfma_f32_16x16x32_bf16 v[140:143], v[100:103], v[160:163], v[140:143]
  s_waitcnt lgkmcnt(0)
  s_waitcnt vmcnt(11)
  v_mfma_f32_16x16x32_bf16 v[104:107], v[64:67], v[164:167], v[104:107]
  ds_read_b128 v[84:87], v60 offset:20480
  s_waitcnt vmcnt(10)
  v_mfma_f32_16x16x32_bf16 v[124:127], v[64:67], v[168:171], v[124:127]
  ds_read_b128 v[88:91], v60 offset:21504
  v_mfma_f32_16x16x32_bf16 v[108:111], v[68:71], v[164:167], v[108:111]
  ds_read_b128 v[92:95], v60 offset:22528
  v_mfma_f32_16x16x32_bf16 v[128:131], v[68:71], v[168:171], v[128:131]
  ds_read_b128 v[96:99], v60 offset:23552
  v_mfma_f32_16x16x32_bf16 v[112:115], v[72:75], v[164:167], v[112:115]
  ds_read_b128 v[100:103], v60 offset:24576
  v_mfma_f32_16x16x32_bf16 v[132:135], v[72:75], v[168:171], v[132:135]
  s_mov_b32 s60, 32768
  buffer_load_dwordx4 a[16:19], v56, s[28:31], s60 offen offset:0 sc1
  v_mfma_f32_16x16x32_bf16 v[116:119], v[76:79], v[164:167], v[116:119]
  v_mfma_f32_16x16x32_bf16 v[136:139], v[76:79], v[168:171], v[136:139]
  s_mov_b32 s60, 32768
  buffer_load_dwordx4 a[20:23], v57, s[28:31], s60 offen offset:0 sc1
  v_mfma_f32_16x16x32_bf16 v[120:123], v[80:83], v[164:167], v[120:123]
  v_mfma_f32_16x16x32_bf16 v[140:143], v[80:83], v[168:171], v[140:143]
  s_waitcnt lgkmcnt(0)
  s_barrier
  v_add_u32 v60, 122880, v18
  s_waitcnt vmcnt(11)
  v_mfma_f32_16x16x32_bf16 v[104:107], v[84:87], v[172:175], v[104:107]
  ds_read_b128 v[64:67], v60 offset:0
  s_waitcnt vmcnt(10)
  v_mfma_f32_16x16x32_bf16 v[124:127], v[84:87], v[176:179], v[124:127]
  ds_read_b128 v[68:71], v60 offset:1024
  v_mfma_f32_16x16x32_bf16 v[108:111], v[88:91], v[172:175], v[108:111]
  ds_read_b128 v[72:75], v60 offset:2048
  v_mfma_f32_16x16x32_bf16 v[128:131], v[88:91], v[176:179], v[128:131]
  ds_read_b128 v[76:79], v60 offset:3072
  v_mfma_f32_16x16x32_bf16 v[112:115], v[92:95], v[172:175], v[112:115]
  ds_read_b128 v[80:83], v60 offset:4096
  v_mfma_f32_16x16x32_bf16 v[132:135], v[92:95], v[176:179], v[132:135]
  s_mov_b32 s60, 32768
  buffer_load_dwordx4 a[24:27], v56, s[28:31], s60 offen offset:2048 sc1
  v_mfma_f32_16x16x32_bf16 v[116:119], v[96:99], v[172:175], v[116:119]
  v_mfma_f32_16x16x32_bf16 v[136:139], v[96:99], v[176:179], v[136:139]
  s_mov_b32 s60, 32768
  buffer_load_dwordx4 a[28:31], v57, s[28:31], s60 offen offset:2048 sc1
  v_mfma_f32_16x16x32_bf16 v[120:123], v[100:103], v[172:175], v[120:123]
  v_mfma_f32_16x16x32_bf16 v[140:143], v[100:103], v[176:179], v[140:143]
  s_waitcnt lgkmcnt(0)
  s_waitcnt vmcnt(11)
  v_mfma_f32_16x16x32_bf16 v[104:107], v[64:67], v[180:183], v[104:107]
  ds_read_b128 v[84:87], v60 offset:10240
  s_waitcnt vmcnt(10)
  v_mfma_f32_16x16x32_bf16 v[124:127], v[64:67], v[184:187], v[124:127]
  ds_read_b128 v[88:91], v60 offset:11264
  v_mfma_f32_16x16x32_bf16 v[108:111], v[68:71], v[180:183], v[108:111]
  ds_read_b128 v[92:95], v60 offset:12288
  v_mfma_f32_16x16x32_bf16 v[128:131], v[68:71], v[184:187], v[128:131]
  ds_read_b128 v[96:99], v60 offset:13312
  v_mfma_f32_16x16x32_bf16 v[112:115], v[72:75], v[180:183], v[112:115]
  ds_read_b128 v[100:103], v60 offset:14336
  v_mfma_f32_16x16x32_bf16 v[132:135], v[72:75], v[184:187], v[132:135]
  s_mov_b32 s60, 36864
  buffer_load_dwordx4 a[32:35], v56, s[28:31], s60 offen offset:0 sc1
  v_mfma_f32_16x16x32_bf16 v[116:119], v[76:79], v[180:183], v[116:119]
  v_mfma_f32_16x16x32_bf16 v[136:139], v[76:79], v[184:187], v[136:139]
  s_mov_b32 s60, 36864
  buffer_load_dwordx4 a[36:39], v57, s[28:31], s60 offen offset:0 sc1
  v_mfma_f32_16x16x32_bf16 v[120:123], v[80:83], v[180:183], v[120:123]
  v_mfma_f32_16x16x32_bf16 v[140:143], v[80:83], v[184:187], v[140:143]
  s_waitcnt lgkmcnt(0)
  s_waitcnt vmcnt(11)
  v_mfma_f32_16x16x32_bf16 v[104:107], v[84:87], v[188:191], v[104:107]
  ds_read_b128 v[64:67], v60 offset:20480
  s_waitcnt vmcnt(10)
  v_mfma_f32_16x16x32_bf16 v[124:127], v[84:87], v[192:195], v[124:127]
  ds_read_b128 v[68:71], v60 offset:21504
  v_mfma_f32_16x16x32_bf16 v[108:111], v[88:91], v[188:191], v[108:111]
  ds_read_b128 v[72:75], v60 offset:22528
  v_mfma_f32_16x16x32_bf16 v[128:131], v[88:91], v[192:195], v[128:131]
  ds_read_b128 v[76:79], v60 offset:23552
  v_mfma_f32_16x16x32_bf16 v[112:115], v[92:95], v[188:191], v[112:115]
  ds_read_b128 v[80:83], v60 offset:24576
  v_mfma_f32_16x16x32_bf16 v[132:135], v[92:95], v[192:195], v[132:135]
  s_mov_b32 s60, 36864
  buffer_load_dwordx4 a[40:43], v56, s[28:31], s60 offen offset:2048 sc1
  v_mfma_f32_16x16x32_bf16 v[116:119], v[96:99], v[188:191], v[116:119]
  v_mfma_f32_16x16x32_bf16 v[136:139], v[96:99], v[192:195], v[136:139]
  s_mov_b32 s60, 36864
  buffer_load_dwordx4 a[44:47], v57, s[28:31], s60 offen offset:2048 sc1
  v_mfma_f32_16x16x32_bf16 v[120:123], v[100:103], v[188:191], v[120:123]
  v_mfma_f32_16x16x32_bf16 v[140:143], v[100:103], v[192:195], v[140:143]
  s_waitcnt lgkmcnt(0)
  s_barrier
  v_add_u32 v60, 0, v18
  s_waitcnt vmcnt(11)
  v_mfma_f32_16x16x32_bf16 v[104:107], v[64:67], a[0:3], v[104:107]
  ds_read_b128 v[84:87], v60 offset:0
  s_waitcnt vmcnt(10)
  v_mfma_f32_16x16x32_bf16 v[124:127], v[64:67], a[4:7], v[124:127]
  ds_read_b128 v[88:91], v60 offset:1024
  v_mfma_f32_16x16x32_bf16 v[108:111], v[68:71], a[0:3], v[108:111]
  ds_read_b128 v[92:95], v60 offset:2048
  v_mfma_f32_16x16x32_bf16 v[128:131], v[68:71], a[4:7], v[128:131]
  ds_read_b128 v[96:99], v60 offset:3072
  v_mfma_f32_16x16x32_bf16 v[112:115], v[72:75], a[0:3], v[112:115]
  ds_read_b128 v[100:103], v60 offset:4096
  v_mfma_f32_16x16x32_bf16 v[132:135], v[72:75], a[4:7], v[132:135]
  s_mov_b32 s60, 40960
  buffer_load_dwordx4 a[48:51], v56, s[28:31], s60 offen offset:0 sc1
  v_mfma_f32_16x16x32_bf16 v[116:119], v[76:79], a[0:3], v[116:119]
  v_mfma_f32_16x16x32_bf16 v[136:139], v[76:79], a[4:7], v[136:139]
  s_mov_b32 s60, 40960
  buffer_load_dwordx4 a[52:55], v57, s[28:31], s60 offen offset:0 sc1
  v_mfma_f32_16x16x32_bf16 v[120:123], v[80:83], a[0:3], v[120:123]
  v_mfma_f32_16x16x32_bf16 v[140:143], v[80:83], a[4:7], v[140:143]
  s_waitcnt lgkmcnt(0)
  s_waitcnt vmcnt(11)
  v_mfma_f32_16x16x32_bf16 v[104:107], v[84:87], a[8:11], v[104:107]
  ds_read_b128 v[64:67], v60 offset:10240
  s_waitcnt vmcnt(10)
  v_mfma_f32_16x16x32_bf16 v[124:127], v[84:87], a[12:15], v[124:127]
  ds_read_b128 v[68:71], v60 offset:11264
  v_mfma_f32_16x16x32_bf16 v[108:111], v[88:91], a[8:11], v[108:111]
  ds_read_b128 v[72:75], v60 offset:12288
  v_mfma_f32_16x16x32_bf16 v[128:131], v[88:91], a[12:15], v[128:131]
  ds_read_b128 v[76:79], v60 offset:13312
  v_mfma_f32_16x16x32_bf16 v[112:115], v[92:95], a[8:11], v[112:115]
  ds_read_b128 v[80:83], v60 offset:14336
  v_mfma_f32_16x16x32_bf16 v[132:135], v[92:95], a[12:15], v[132:135]
  s_mov_b32 s60, 40960
  buffer_load_dwordx4 a[56:59], v56, s[28:31], s60 offen offset:2048 sc1
  v_mfma_f32_16x16x32_bf16 v[116:119], v[96:99], a[8:11], v[116:119]
  v_mfma_f32_16x16x32_bf16 v[136:139], v[96:99], a[12:15], v[136:139]
  s_mov_b32 s60, 40960
  buffer_load_dwordx4 v[144:147], v57, s[28:31], s60 offen offset:2048 sc1
  v_mfma_f32_16x16x32_bf16 v[120:123], v[100:103], a[8:11], v[120:123]
  v_mfma_f32_16x16x32_bf16 v[140:143], v[100:103], a[12:15], v[140:143]
  s_waitcnt lgkmcnt(0)
  s_waitcnt vmcnt(11)
  v_mfma_f32_16x16x32_bf16 v[104:107], v[64:67], a[16:19], v[104:107]
  ds_read_b128 v[84:87], v60 offset:20480
  s_waitcnt vmcnt(10)
  v_mfma_f32_16x16x32_bf16 v[124:127], v[64:67], a[20:23], v[124:127]
  ds_read_b128 v[88:91], v60 offset:21504
  v_mfma_f32_16x16x32_bf16 v[108:111], v[68:71], a[16:19], v[108:111]
  ds_read_b128 v[92:95], v60 offset:22528
  v_mfma_f32_16x16x32_bf16 v[128:131], v[68:71], a[20:23], v[128:131]
  ds_read_b128 v[96:99], v60 offset:23552
  v_mfma_f32_16x16x32_bf16 v[112:115], v[72:75], a[16:19], v[112:115]
  ds_read_b128 v[100:103], v60 offset:24576
  v_mfma_f32_16x16x32_bf16 v[132:135], v[72:75], a[20:23], v[132:135]
  s_mov_b32 s60, 45056
  buffer_load_dwordx4 v[148:151], v56, s[28:31], s60 offen offset:0 sc1
  v_mfma_f32_16x16x32_bf16 v[116:119], v[76:79], a[16:19], v[116:119]
  v_mfma_f32_16x16x32_bf16 v[136:139], v[76:79], a[20:23], v[136:139]
  s_mov_b32 s60, 45056
  buffer_load_dwordx4 v[152:155], v57, s[28:31], s60 offen offset:0 sc1
  v_mfma_f32_16x16x32_bf16 v[120:123], v[80:83], a[16:19], v[120:123]
  v_mfma_f32_16x16x32_bf16 v[140:143], v[80:83], a[20:23], v[140:143]
  s_waitcnt lgkmcnt(0)
  s_barrier
  v_add_u32 v60, 30720, v18
  s_waitcnt vmcnt(11)
  v_mfma_f32_16x16x32_bf16 v[104:107], v[84:87], a[24:27], v[104:107]
  ds_read_b128 v[64:67], v60 offset:0
  s_waitcnt vmcnt(10)
  v_mfma_f32_16x16x32_bf16 v[124:127], v[84:87], a[28:31], v[124:127]
  ds_read_b128 v[68:71], v60 offset:1024
  v_mfma_f32_16x16x32_bf16 v[108:111], v[88:91], a[24:27], v[108:111]
  ds_read_b128 v[72:75], v60 offset:2048
  v_mfma_f32_16x16x32_bf16 v[128:131], v[88:91], a[28:31], v[128:131]
  ds_read_b128 v[76:79], v60 offset:3072
  v_mfma_f32_16x16x32_bf16 v[112:115], v[92:95], a[24:27], v[112:115]
  ds_read_b128 v[80:83], v60 offset:4096
  v_mfma_f32_16x16x32_bf16 v[132:135], v[92:95], a[28:31], v[132:135]
  s_mov_b32 s60, 45056
  buffer_load_dwordx4 v[156:159], v56, s[28:31], s60 offen offset:2048 sc1
  v_mfma_f32_16x16x32_bf16 v[116:119], v[96:99], a[24:27], v[116:119]
  v_mfma_f32_16x16x32_bf16 v[136:139], v[96:99], a[28:31], v[136:139]
  s_mov_b32 s60, 45056
  buffer_load_dwordx4 v[160:163], v57, s[28:31], s60 offen offset:2048 sc1
  v_mfma_f32_16x16x32_bf16 v[120:123], v[100:103], a[24:27], v[120:123]
  v_mfma_f32_16x16x32_bf16 v[140:143], v[100:103], a[28:31], v[140:143]
  s_waitcnt lgkmcnt(0)
  s_waitcnt vmcnt(11)
  v_mfma_f32_16x16x32_bf16 v[104:107], v[64:67], a[32:35], v[104:107]
  ds_read_b128 v[84:87], v60 offset:10240
  s_waitcnt vmcnt(10)
  v_mfma_f32_16x16x32_bf16 v[124:127], v[64:67], a[36:39], v[124:127]
  ds_read_b128 v[88:91], v60 offset:11264
  v_mfma_f32_16x16x32_bf16 v[108:111], v[68:71], a[32:35], v[108:111]
  ds_read_b128 v[92:95], v60 offset:12288
  v_mfma_f32_16x16x32_bf16 v[128:131], v[68:71], a[36:39], v[128:131]
  ds_read_b128 v[96:99], v60 offset:13312
  v_mfma_f32_16x16x32_bf16 v[112:115], v[72:75], a[32:35], v[112:115]
  ds_read_b128 v[100:103], v60 offset:14336
  v_mfma_f32_16x16x32_bf16 v[132:135], v[72:75], a[36:39], v[132:135]
  buffer_load_dwordx2 v[20:21], v7, s[48:51], 0 offen offset:0
  v_mfma_f32_16x16x32_bf16 v[116:119], v[76:79], a[32:35], v[116:119]
  buffer_load_dwordx2 v[22:23], v7, s[48:51], 0 offen offset:32
  v_mfma_f32_16x16x32_bf16 v[136:139], v[76:79], a[36:39], v[136:139]
  buffer_load_dwordx2 v[24:25], v7, s[48:51], 0 offen offset:64
  v_mfma_f32_16x16x32_bf16 v[120:123], v[80:83], a[32:35], v[120:123]
  buffer_load_dwordx2 v[26:27], v7, s[48:51], 0 offen offset:96
  v_mfma_f32_16x16x32_bf16 v[140:143], v[80:83], a[36:39], v[140:143]
  buffer_load_dwordx2 v[28:29], v7, s[48:51], 0 offen offset:128
  s_waitcnt lgkmcnt(0)
  s_waitcnt vmcnt(14)
  v_mfma_f32_16x16x32_bf16 v[104:107], v[84:87], a[40:43], v[104:107]
  ds_read_b128 v[64:67], v60 offset:20480
  s_waitcnt vmcnt(13)
  v_mfma_f32_16x16x32_bf16 v[124:127], v[84:87], a[44:47], v[124:127]
  ds_read_b128 v[68:71], v60 offset:21504
  v_mfma_f32_16x16x32_bf16 v[108:111], v[88:91], a[40:43], v[108:111]
  ds_read_b128 v[72:75], v60 offset:22528
  v_mfma_f32_16x16x32_bf16 v[128:131], v[88:91], a[44:47], v[128:131]
  ds_read_b128 v[76:79], v60 offset:23552
  v_mfma_f32_16x16x32_bf16 v[112:115], v[92:95], a[40:43], v[112:115]
  ds_read_b128 v[80:83], v60 offset:24576
  v_mfma_f32_16x16x32_bf16 v[132:135], v[92:95], a[44:47], v[132:135]
  v_mfma_f32_16x16x32_bf16 v[116:119], v[96:99], a[40:43], v[116:119]
  v_mfma_f32_16x16x32_bf16 v[136:139], v[96:99], a[44:47], v[136:139]
  v_mfma_f32_16x16x32_bf16 v[120:123], v[100:103], a[40:43], v[120:123]
  v_mfma_f32_16x16x32_bf16 v[140:143], v[100:103], a[44:47], v[140:143]
  s_waitcnt lgkmcnt(0)
  s_barrier
  v_add_u32 v60, 61440, v18
  s_waitcnt vmcnt(12)
  v_mfma_f32_16x16x32_bf16 v[104:107], v[64:67], a[48:51], v[104:107]
  ds_read_b128 v[84:87], v60 offset:0
  s_waitcnt vmcnt(11)
  v_mfma_f32_16x16x32_bf16 v[124:127], v[64:67], a[52:55], v[124:127]
  ds_read_b128 v[88:91], v60 offset:1024
  v_mfma_f32_16x16x32_bf16 v[108:111], v[68:71], a[48:51], v[108:111]
  ds_read_b128 v[92:95], v60 offset:2048
  v_mfma_f32_16x16x32_bf16 v[128:131], v[68:71], a[52:55], v[128:131]
  ds_read_b128 v[96:99], v60 offset:3072
  v_mfma_f32_16x16x32_bf16 v[112:115], v[72:75], a[48:51], v[112:115]
  ds_read_b128 v[100:103], v60 offset:4096
  v_mfma_f32_16x16x32_bf16 v[132:135], v[72:75], a[52:55], v[132:135]
  ds_read_b64_tr_b16 v[32:33], v58 offset:0
  v_mfma_f32_16x16x32_bf16 v[116:119], v[76:79], a[48:51], v[116:119]
  ds_read_b64_tr_b16 v[34:35], v58 offset:2048
  v_mfma_f32_16x16x32_bf16 v[136:139], v[76:79], a[52:55], v[136:139]
  ds_read_b64_tr_b16 v[36:37], v58 offset:4096
  v_mfma_f32_16x16x32_bf16 v[120:123], v[80:83], a[48:51], v[120:123]
  ds_read_b64_tr_b16 v[38:39], v58 offset:6144
  v_mfma_f32_16x16x32_bf16 v[140:143], v[80:83], a[52:55], v[140:143]
  ds_read_b64_tr_b16 v[40:41], v58 offset:8192
  s_waitcnt lgkmcnt(0)
  s_waitcnt vmcnt(10)
  v_mfma_f32_16x16x32_bf16 v[104:107], v[84:87], a[56:59], v[104:107]
  ds_read_b128 v[64:67], v60 offset:10240
  s_waitcnt vmcnt(9)
  v_mfma_f32_16x16x32_bf16 v[124:127], v[84:87], v[144:147], v[124:127]
  ds_read_b128 v[68:71], v60 offset:11264
  v_mfma_f32_16x16x32_bf16 v[108:111], v[88:91], a[56:59], v[108:111]
  ds_read_b128 v[72:75], v60 offset:12288
  v_mfma_f32_16x16x32_bf16 v[128:131], v[88:91], v[144:147], v[128:131]
  ds_read_b128 v[76:79], v60 offset:13312
  v_mfma_f32_16x16x32_bf16 v[112:115], v[92:95], a[56:59], v[112:115]
  ds_read_b128 v[80:83], v60 offset:14336
  v_mfma_f32_16x16x32_bf16 v[132:135], v[92:95], v[144:147], v[132:135]
  v_mfma_f32_16x16x32_bf16 v[116:119], v[96:99], a[56:59], v[116:119]
  v_mfma_f32_16x16x32_bf16 v[136:139], v[96:99], v[144:147], v[136:139]
  v_mfma_f32_16x16x32_bf16 v[120:123], v[100:103], a[56:59], v[120:123]
  v_mfma_f32_16x16x32_bf16 v[140:143], v[100:103], v[144:147], v[140:143]
  s_waitcnt lgkmcnt(0)
  s_waitcnt vmcnt(8)
  v_mfma_f32_16x16x32_bf16 v[104:107], v[64:67], v[148:151], v[104:107]
  ds_read_b128 v[84:87], v60 offset:20480
  s_waitcnt vmcnt(7)
  v_mfma_f32_16x16x32_bf16 v[124:127], v[64:67], v[152:155], v[124:127]
  ds_read_b128 v[88:91], v60 offset:21504
  v_mfma_f32_16x16x32_bf16 v[108:111], v[68:71], v[148:151], v[108:111]
  ds_read_b128 v[92:95], v60 offset:22528
  v_mfma_f32_16x16x32_bf16 v[128:131], v[68:71], v[152:155], v[128:131]
  ds_read_b128 v[96:99], v60 offset:23552
  v_mfma_f32_16x16x32_bf16 v[112:115], v[72:75], v[148:151], v[112:115]
  ds_read_b128 v[100:103], v60 offset:24576
  v_mfma_f32_16x16x32_bf16 v[132:135], v[72:75], v[152:155], v[132:135]
  s_waitcnt vmcnt(0)
  v_lshlrev_b32 v164, 16, v20
  v_and_b32 v165, 0xffff0000, v20
  v_lshlrev_b32 v166, 16, v21
  v_and_b32 v167, 0xffff0000, v21
  v_lshlrev_b32 v42, 16, v32
  v_and_b32 v43, 0xffff0000, v32
  v_mfma_f32_16x16x32_bf16 v[116:119], v[76:79], v[148:151], v[116:119]
  v_lshlrev_b32 v44, 16, v33
  v_and_b32 v45, 0xffff0000, v33
  v_pk_add_f32 v[164:165], v[164:165], v[42:43]
  v_pk_add_f32 v[166:167], v[166:167], v[44:45]
  v_lshlrev_b32 v168, 16, v22
  v_and_b32 v169, 0xffff0000, v22
  v_mfma_f32_16x16x32_bf16 v[136:139], v[76:79], v[152:155], v[136:139]
  v_lshlrev_b32 v170, 16, v23
  v_and_b32 v171, 0xffff0000, v23
  v_lshlrev_b32 v42, 16, v34
  v_and_b32 v43, 0xffff0000, v34
  v_lshlrev_b32 v44, 16, v35
  v_and_b32 v45, 0xffff0000, v35
  v_mfma_f32_16x16x32_bf16 v[120:123], v[80:83], v[148:151], v[120:123]
  v_pk_add_f32 v[168:169], v[168:169], v[42:43]
  v_pk_add_f32 v[170:171], v[170:171], v[44:45]
  v_lshlrev_b32 v172, 16, v24
  v_and_b32 v173, 0xffff0000, v24
  v_lshlrev_b32 v174, 16, v25
  v_and_b32 v175, 0xffff0000, v25
  v_mfma_f32_16x16x32_bf16 v[140:143], v[80:83], v[152:155], v[140:143]
  v_lshlrev_b32 v42, 16, v36
  v_and_b32 v43, 0xffff0000, v36
  v_lshlrev_b32 v44, 16, v37
  v_and_b32 v45, 0xffff0000, v37
  v_pk_add_f32 v[172:173], v[172:173], v[42:43]
  v_pk_add_f32 v[174:175], v[174:175], v[44:45]
  s_waitcnt lgkmcnt(0)
  v_mfma_f32_16x16x32_bf16 v[104:107], v[84:87], v[156:159], v[104:107]
  v_lshlrev_b32 v176, 16, v26
  v_and_b32 v177, 0xffff0000, v26
  v_mfma_f32_16x16x32_bf16 v[124:127], v[84:87], v[160:163], v[124:127]
  v_lshlrev_b32 v178, 16, v27
  v_and_b32 v179, 0xffff0000, v27
  v_mfma_f32_16x16x32_bf16 v[108:111], v[88:91], v[156:159], v[108:111]
  v_lshlrev_b32 v42, 16, v38
  v_and_b32 v43, 0xffff0000, v38
  v_mfma_f32_16x16x32_bf16 v[128:131], v[88:91], v[160:163], v[128:131]
  v_lshlrev_b32 v44, 16, v39
  v_and_b32 v45, 0xffff0000, v39
  v_mfma_f32_16x16x32_bf16 v[112:115], v[92:95], v[156:159], v[112:115]
  v_pk_add_f32 v[176:177], v[176:177], v[42:43]
  v_pk_add_f32 v[178:179], v[178:179], v[44:45]
  v_mfma_f32_16x16x32_bf16 v[132:135], v[92:95], v[160:163], v[132:135]
  v_lshlrev_b32 v180, 16, v28
  v_and_b32 v181, 0xffff0000, v28
  v_mfma_f32_16x16x32_bf16 v[116:119], v[96:99], v[156:159], v[116:119]
  v_lshlrev_b32 v182, 16, v29
  v_and_b32 v183, 0xffff0000, v29
  v_mfma_f32_16x16x32_bf16 v[136:139], v[96:99], v[160:163], v[136:139]
  v_lshlrev_b32 v42, 16, v40
  v_and_b32 v43, 0xffff0000, v40
  v_mfma_f32_16x16x32_bf16 v[120:123], v[100:103], v[156:159], v[120:123]
  v_lshlrev_b32 v44, 16, v41
  v_and_b32 v45, 0xffff0000, v41
  v_mfma_f32_16x16x32_bf16 v[140:143], v[100:103], v[160:163], v[140:143]
  v_pk_add_f32 v[180:181], v[180:181], v[42:43]
  v_pk_add_f32 v[182:183], v[182:183], v[44:45]
  s_and_b32 s62, s33, 1
  s_mul_i32 s62, s62, 10240
  s_add_u32 s62, s62, 92160
  v_add_u32 v19, s62, v19
  s_cmp_ge_u32 s33, 2
  s_cbranch_scc1 KB_X1
  ds_write_b128 v19, v[124:127] offset:0
  ds_write_b128 v19, v[128:131] offset:1024
  ds_write_b128 v19, v[132:135] offset:2048
  ds_write_b128 v19, v[136:139] offset:3072
  ds_write_b128 v19, v[140:143] offset:4096
  s_waitcnt lgkmcnt(0)
  s_barrier
  ds_read_b128 v[64:67], v19 offset:5120
  ds_read_b128 v[68:71], v19 offset:6144
  ds_read_b128 v[72:75], v19 offset:7168
  ds_read_b128 v[76:79], v19 offset:8192
  ds_read_b128 v[80:83], v19 offset:9216
  s_branch KB_X2
KB_X1:
  ds_write_b128 v19, v[104:107] offset:5120
  ds_write_b128 v19, v[108:111] offset:6144
  ds_write_b128 v19, v[112:115] offset:7168
  ds_write_b128 v19, v[116:119] offset:8192
  ds_write_b128 v19, v[120:123] offset:9216
  s_waitcnt lgkmcnt(0)
  s_barrier
  ds_read_b128 v[64:67], v19 offset:0
  ds_read_b128 v[68:71], v19 offset:1024
  ds_read_b128 v[72:75], v19 offset:2048
  ds_read_b128 v[76:79], v19 offset:3072
  ds_read_b128 v[80:83], v19 offset:4096
  v_mov_b32 v104, v124
  v_mov_b32 v105, v125
  v_mov_b32 v106, v126
  v_mov_b32 v107, v127
  v_mov_b32 v108, v128
  v_mov_b32 v109, v129
  v_mov_b32 v110, v130
  v_mov_b32 v111, v131
  v_mov_b32 v112, v132
  v_mov_b32 v113, v133
  v_mov_b32 v114, v134
  v_mov_b32 v115, v135
  v_mov_b32 v116, v136
  v_mov_b32 v117, v137
  v_mov_b32 v118, v138
  v_mov_b32 v119, v139
  v_mov_b32 v120, v140
  v_mov_b32 v121, v141
  v_mov_b32 v122, v142
  v_mov_b32 v123, v143
KB_X2:
  s_waitcnt lgkmcnt(4)
  v_pk_add_f32 v[104:105], v[104:105], v[164:165]
  v_pk_add_f32 v[106:107], v[106:107], v[166:167]
  v_pk_add_f32 v[104:105], v[104:105], v[64:65]
  v_pk_add_f32 v[106:107], v[106:107], v[66:67]
  v_cvt_pk_bf16_f32 v46, v104, v105
  v_cvt_pk_bf16_f32 v47, v106, v107
  buffer_store_dwordx2 v[46:47], v59, s[52:55], 0 offen offset:0
  s_waitcnt lgkmcnt(3)
  v_pk_add_f32 v[108:109], v[108:109], v[168:169]
  v_pk_add_f32 v[110:111], v[110:111], v[170:171]
  v_pk_add_f32 v[108:109], v[108:109], v[68:69]
  v_pk_add_f32 v[110:111], v[110:111], v[70:71]
  v_cvt_pk_bf16_f32 v48, v108, v109
  v_cvt_pk_bf16_f32 v49, v110, v111
  buffer_store_dwordx2 v[48:49], v59, s[52:55], 0 offen offset:32
  s_waitcnt lgkmcnt(2)
  v_pk_add_f32 v[112:113], v[112:113], v[172:173]
  v_pk_add_f32 v[114:115], v[114:115], v[174:175]
  v_pk_add_f32 v[112:113], v[112:113], v[72:73]
  v_pk_add_f32 v[114:115], v[114:115], v[74:75]
  v_cvt_pk_bf16_f32 v50, v112, v113
  v_cvt_pk_bf16_f32 v51, v114, v115
  buffer_store_dwordx2 v[50:51], v59, s[52:55], 0 offen offset:64
  s_waitcnt lgkmcnt(1)
  v_pk_add_f32 v[116:117], v[116:117], v[176:177]
  v_pk_add_f32 v[118:119], v[118:119], v[178:179]
  v_pk_add_f32 v[116:117], v[116:117], v[76:77]
  v_pk_add_f32 v[118:119], v[118:119], v[78:79]
  v_cvt_pk_bf16_f32 v52, v116, v117
  v_cvt_pk_bf16_f32 v53, v118, v119
  buffer_store_dwordx2 v[52:53], v59, s[52:55], 0 offen offset:96
  s_waitcnt lgkmcnt(0)
  v_pk_add_f32 v[120:121], v[120:121], v[180:181]
  v_pk_add_f32 v[122:123], v[122:123], v[182:183]
  v_pk_add_f32 v[120:121], v[120:121], v[80:81]
  v_pk_add_f32 v[122:123], v[122:123], v[82:83]
  v_cvt_pk_bf16_f32 v54, v120, v121
  v_cvt_pk_bf16_f32 v55, v122, v123
  buffer_store_dwordx2 v[54:55], v59, s[52:55], 0 offen offset:128
  s_endpgm
KB_LOADER:
  s_sub_u32 s39, s33, 4
  v_lshrrev_b32 v3, 4, v1
  v_and_b32 v4, 15, v1
  v_add_u32 v5, 0, v3
  v_lshrrev_b32 v6, 1, v4
  v_xor_b32 v6, v6, v5
  v_lshlrev_b32 v6, 5, v6
  v_and_b32 v7, 1, v4
  v_lshl_add_u32 v6, v7, 4, v6
  v_lshl_add_u32 v6, v3, 12, v6
  s_lshl_b32 s60, s34, 8
  v_add_u32 v10, s60, v6
  v_add_u32 v5, 4, v3
  v_lshrrev_b32 v6, 1, v4
  v_xor_b32 v6, v6, v5
  v_lshlrev_b32 v6, 5, v6
  v_and_b32 v7, 1, v4
  v_lshl_add_u32 v6, v7, 4, v6
  v_lshl_add_u32 v6, v3, 12, v6
  s_lshl_b32 s60, s34, 8
  v_add_u32 v11, s60, v6
  s_mul_i32 s60, s35, 122880
  v_lshl_add_u32 v12, v1, 4, s60
  s_mul_i32 s60, s37, 245760
  v_lshl_add_u32 v16, v1, 4, s60
  s_waitcnt lgkmcnt(0)
  s_add_u32 s12, s42, 14680064
  s_addc_u32 s13, s43, 0
  s_and_b32 s13, s13, 0xffff
  s_mov_b32 s14, 1966080
  s_mov_b32 s15, 0x20000
  s_add_u32 s20, s42, 5242880
  s_addc_u32 s21, s43, 0
  s_and_b32 s21, s21, 0xffff
  s_mov_b32 s22, 2621440
  s_mov_b32 s23, 0x20000
  s_add_u32 s44, s42, 16777216
  s_addc_u32 s45, s43, 0
  s_and_b32 s45, s45, 0xffff
  s_mov_b32 s46, 1966080
  s_mov_b32 s47, 0x20000
  s_cmp_eq_u32 s39, 0
  s_cbranch_scc0 KB_L1
  s_mov_b32 m0, 0
  s_mov_b32 s60, 0
  buffer_load_dwordx4 v10, s[20:23], s60 offen lds
  s_mov_b32 m0, 1024
  s_mov_b32 s60, 16384
  buffer_load_dwordx4 v11, s[20:23], s60 offen lds
  s_mov_b32 m0, 2048
  s_mov_b32 s60, 32768
  buffer_load_dwordx4 v10, s[20:23], s60 offen lds
  s_mov_b32 m0, 3072
  s_mov_b32 s60, 49152
  buffer_load_dwordx4 v11, s[20:23], s60 offen lds
  s_mov_b32 m0, 16384
  s_mov_b32 s60, 0
  buffer_load_dwordx4 v12, s[12:15], s60 offen lds
  s_mov_b32 m0, 17408
  s_mov_b32 s60, 1024
  buffer_load_dwordx4 v12, s[12:15], s60 offen lds
  s_mov_b32 m0, 18432
  s_mov_b32 s60, 2048
  buffer_load_dwordx4 v12, s[12:15], s60 offen lds
  v_lshrrev_b32 v5, 3, v1
  v_and_b32 v6, 7, v1
  v_lshlrev_b32 v5, 12, v5
  v_lshl_add_u32 v5, v6, 4, v5
  s_mul_i32 s60, s37, 80
  s_lshl_b32 s60, s60, 12
  s_lshl_b32 s61, s38, 7
  s_add_u32 s60, s60, s61
  v_add_u32 v24, s60, v5
  s_mov_b32 m0, 30720
  s_mov_b32 s60, 262144
  buffer_load_dwordx4 v10, s[20:23], s60 offen lds
  s_mov_b32 m0, 31744
  s_mov_b32 s60, 278528
  buffer_load_dwordx4 v11, s[20:23], s60 offen lds
  s_mov_b32 m0, 32768
  s_mov_b32 s60, 294912
  buffer_load_dwordx4 v10, s[20:23], s60 offen lds
  s_mov_b32 m0, 33792
  s_mov_b32 s60, 311296
  buffer_load_dwordx4 v11, s[20:23], s60 offen lds
  s_mov_b32 m0, 47104
  s_mov_b32 s60, 12288
  buffer_load_dwordx4 v12, s[12:15], s60 offen lds
  s_mov_b32 m0, 48128
  s_mov_b32 s60, 13312
  buffer_load_dwordx4 v12, s[12:15], s60 offen lds
  s_mov_b32 m0, 49152
  s_mov_b32 s60, 14336
  buffer_load_dwordx4 v12, s[12:15], s60 offen lds
  s_waitcnt vmcnt(7)
  s_barrier
  s_mov_b32 m0, 61440
  s_mov_b32 s60, 524288
  buffer_load_dwordx4 v10, s[20:23], s60 offen lds
  s_mov_b32 m0, 62464
  s_mov_b32 s60, 540672
  buffer_load_dwordx4 v11, s[20:23], s60 offen lds
  s_mov_b32 m0, 63488
  s_mov_b32 s60, 557056
  buffer_load_dwordx4 v10, s[20:23], s60 offen lds
  s_mov_b32 m0, 64512
  s_mov_b32 s60, 573440
  buffer_load_dwordx4 v11, s[20:23], s60 offen lds
  s_mov_b32 m0, 77824
  s_mov_b32 s60, 24576
  buffer_load_dwordx4 v12, s[12:15], s60 offen lds
  s_mov_b32 m0, 78848
  s_mov_b32 s60, 25600
  buffer_load_dwordx4 v12, s[12:15], s60 offen lds
  s_mov_b32 m0, 79872
  s_mov_b32 s60, 26624
  buffer_load_dwordx4 v12, s[12:15], s60 offen lds
  s_waitcnt vmcnt(7)
  s_barrier
  s_mov_b32 m0, 92160
  s_mov_b32 s60, 786432
  buffer_load_dwordx4 v10, s[20:23], s60 offen lds
  s_mov_b32 m0, 93184
  s_mov_b32 s60, 802816
  buffer_load_dwordx4 v11, s[20:23], s60 offen lds
  s_mov_b32 m0, 94208
  s_mov_b32 s60, 819200
  buffer_load_dwordx4 v10, s[20:23], s60 offen lds
  s_mov_b32 m0, 95232
  s_mov_b32 s60, 835584
  buffer_load_dwordx4 v11, s[20:23], s60 offen lds
  s_mov_b32 m0, 108544
  s_mov_b32 s60, 36864
  buffer_load_dwordx4 v12, s[12:15], s60 offen lds
  s_mov_b32 m0, 109568
  s_mov_b32 s60, 37888
  buffer_load_dwordx4 v12, s[12:15], s60 offen lds
  s_mov_b32 m0, 110592
  s_mov_b32 s60, 38912
  buffer_load_dwordx4 v12, s[12:15], s60 offen lds
  s_waitcnt vmcnt(7)
  s_barrier
  s_mov_b32 m0, 122880
  s_mov_b32 s60, 1048576
  buffer_load_dwordx4 v10, s[20:23], s60 offen lds
  s_mov_b32 m0, 123904
  s_mov_b32 s60, 1064960
  buffer_load_dwordx4 v11, s[20:23], s60 offen lds
  s_mov_b32 m0, 124928
  s_mov_b32 s60, 1081344
  buffer_load_dwordx4 v10, s[20:23], s60 offen lds
  s_mov_b32 m0, 125952
  s_mov_b32 s60, 1097728
  buffer_load_dwordx4 v11, s[20:23], s60 offen lds
  s_mov_b32 m0, 139264
  s_mov_b32 s60, 49152
  buffer_load_dwordx4 v12, s[12:15], s60 offen lds
  s_mov_b32 m0, 140288
  s_mov_b32 s60, 50176
  buffer_load_dwordx4 v12, s[12:15], s60 offen lds
  s_mov_b32 m0, 141312
  s_mov_b32 s60, 51200
  buffer_load_dwordx4 v12, s[12:15], s60 offen lds
  s_waitcnt vmcnt(7)
  s_barrier
  s_mov_b32 m0, 0
  s_mov_b32 s60, 1310720
  buffer_load_dwordx4 v10, s[20:23], s60 offen lds
  s_mov_b32 m0, 1024
  s_mov_b32 s60, 1327104
  buffer_load_dwordx4 v11, s[20:23], s60 offen lds
  s_mov_b32 m0, 2048
  s_mov_b32 s60, 1343488
  buffer_load_dwordx4 v10, s[20:23], s60 offen lds
  s_mov_b32 m0, 3072
  s_mov_b32 s60, 1359872
  buffer_load_dwordx4 v11, s[20:23], s60 offen lds
  s_mov_b32 m0, 16384
  s_mov_b32 s60, 61440
  buffer_load_dwordx4 v12, s[12:15], s60 offen lds
  s_mov_b32 m0, 17408
  s_mov_b32 s60, 62464
  buffer_load_dwordx4 v12, s[12:15], s60 offen lds
  s_mov_b32 m0, 18432
  s_mov_b32 s60, 63488
  buffer_load_dwordx4 v12, s[12:15], s60 offen lds
  s_waitcnt vmcnt(7)
  s_barrier
  s_mov_b32 m0, 30720
  s_mov_b32 s60, 1572864
  buffer_load_dwordx4 v10, s[20:23], s60 offen lds
  s_mov_b32 m0, 31744
  s_mov_b32 s60, 1589248
  buffer_load_dwordx4 v11, s[20:23], s60 offen lds
  s_mov_b32 m0, 32768
  s_mov_b32 s60, 1605632
  buffer_load_dwordx4 v10, s[20:23], s60 offen lds
  s_mov_b32 m0, 33792
  s_mov_b32 s60, 1622016
  buffer_load_dwordx4 v11, s[20:23], s60 offen lds
  s_mov_b32 m0, 47104
  s_mov_b32 s60, 73728
  buffer_load_dwordx4 v12, s[12:15], s60 offen lds
  s_mov_b32 m0, 48128
  s_mov_b32 s60, 74752
  buffer_load_dwordx4 v12, s[12:15], s60 offen lds
  s_mov_b32 m0, 49152
  s_mov_b32 s60, 75776
  buffer_load_dwordx4 v12, s[12:15], s60 offen lds
  s_waitcnt vmcnt(7)
  s_barrier
  s_mov_b32 m0, 61440
  s_mov_b32 s60, 1835008
  buffer_load_dwordx4 v10, s[20:23], s60 offen lds
  s_mov_b32 m0, 62464
  s_mov_b32 s60, 1851392
  buffer_load_dwordx4 v11, s[20:23], s60 offen lds
  s_mov_b32 m0, 63488
  s_mov_b32 s60, 1867776
  buffer_load_dwordx4 v10, s[20:23], s60 offen lds
  s_mov_b32 m0, 64512
  s_mov_b32 s60, 1884160
  buffer_load_dwordx4 v11, s[20:23], s60 offen lds
  s_mov_b32 m0, 77824
  s_mov_b32 s60, 86016
  buffer_load_dwordx4 v12, s[12:15], s60 offen lds
  s_mov_b32 m0, 78848
  s_mov_b32 s60, 87040
  buffer_load_dwordx4 v12, s[12:15], s60 offen lds
  s_mov_b32 m0, 79872
  s_mov_b32 s60, 88064
  buffer_load_dwordx4 v12, s[12:15], s60 offen lds
  s_waitcnt vmcnt(7)
  s_barrier
  s_mov_b32 m0, 92160
  s_mov_b32 s60, 2097152
  buffer_load_dwordx4 v10, s[20:23], s60 offen lds
  s_mov_b32 m0, 93184
  s_mov_b32 s60, 2113536
  buffer_load_dwordx4 v11, s[20:23], s60 offen lds
  s_mov_b32 m0, 94208
  s_mov_b32 s60, 2129920
  buffer_load_dwordx4 v10, s[20:23], s60 offen lds
  s_mov_b32 m0, 95232
  s_mov_b32 s60, 2146304
  buffer_load_dwordx4 v11, s[20:23], s60 offen lds
  s_mov_b32 m0, 108544
  s_mov_b32 s60, 98304
  buffer_load_dwordx4 v12, s[12:15], s60 offen lds
  s_mov_b32 m0, 109568
  s_mov_b32 s60, 99328
  buffer_load_dwordx4 v12, s[12:15], s60 offen lds
  s_mov_b32 m0, 110592
  s_mov_b32 s60, 100352
  buffer_load_dwordx4 v12, s[12:15], s60 offen lds
  s_waitcnt vmcnt(7)
  s_barrier
  s_mov_b32 m0, 122880
  s_mov_b32 s60, 2359296
  buffer_load_dwordx4 v10, s[20:23], s60 offen lds
  s_mov_b32 m0, 123904
  s_mov_b32 s60, 2375680
  buffer_load_dwordx4 v11, s[20:23], s60 offen lds
  s_mov_b32 m0, 124928
  s_mov_b32 s60, 2392064
  buffer_load_dwordx4 v10, s[20:23], s60 offen lds
  s_mov_b32 m0, 125952
  s_mov_b32 s60, 2408448
  buffer_load_dwordx4 v11, s[20:23], s60 offen lds
  s_mov_b32 m0, 139264
  s_mov_b32 s60, 110592
  buffer_load_dwordx4 v12, s[12:15], s60 offen lds
  s_mov_b32 m0, 140288
  s_mov_b32 s60, 111616
  buffer_load_dwordx4 v12, s[12:15], s60 offen lds
  s_mov_b32 m0, 141312
  s_mov_b32 s60, 112640
  buffer_load_dwordx4 v12, s[12:15], s60 offen lds
  s_waitcnt vmcnt(7)
  s_barrier
  s_mov_b32 m0, 0
  s_mov_b32 s60, 0
  buffer_load_dwordx4 v16, s[44:47], s60 offen lds
  s_mov_b32 m0, 4096
  s_mov_b32 s60, 4096
  buffer_load_dwordx4 v16, s[44:47], s60 offen lds
  s_mov_b32 m0, 8192
  s_mov_b32 s60, 8192
  buffer_load_dwordx4 v16, s[44:47], s60 offen lds
  s_mov_b32 m0, 12288
  s_mov_b32 s60, 12288
  buffer_load_dwordx4 v16, s[44:47], s60 offen lds
  s_mov_b32 m0, 16384
  s_mov_b32 s60, 16384
  buffer_load_dwordx4 v16, s[44:47], s60 offen lds
  s_mov_b32 m0, 20480
  s_mov_b32 s60, 20480
  buffer_load_dwordx4 v16, s[44:47], s60 offen lds
  s_mov_b32 m0, 24576
  s_mov_b32 s60, 24576
  buffer_load_dwordx4 v16, s[44:47], s60 offen lds
  s_mov_b32 m0, 28672
  s_mov_b32 s60, 28672
  buffer_load_dwordx4 v16, s[44:47], s60 offen lds
  s_waitcnt vmcnt(8)
  s_barrier
  s_mov_b32 m0, 30720
  s_mov_b32 s60, 30720
  buffer_load_dwordx4 v16, s[44:47], s60 offen lds
  s_mov_b32 m0, 34816
  s_mov_b32 s60, 34816
  buffer_load_dwordx4 v16, s[44:47], s60 offen lds
  s_mov_b32 m0, 38912
  s_mov_b32 s60, 38912
  buffer_load_dwordx4 v16, s[44:47], s60 offen lds
  s_mov_b32 m0, 43008
  s_mov_b32 s60, 43008
  buffer_load_dwordx4 v16, s[44:47], s60 offen lds
  s_mov_b32 m0, 47104
  s_mov_b32 s60, 47104
  buffer_load_dwordx4 v16, s[44:47], s60 offen lds
  s_mov_b32 m0, 51200
  s_mov_b32 s60, 51200
  buffer_load_dwordx4 v16, s[44:47], s60 offen lds
  s_mov_b32 m0, 55296
  s_mov_b32 s60, 55296
  buffer_load_dwordx4 v16, s[44:47], s60 offen lds
  s_mov_b32 m0, 59392
  s_mov_b32 s60, 59392
  buffer_load_dwordx4 v16, s[44:47], s60 offen lds
  s_barrier
  s_mov_b32 m0, 61440
  s_mov_b32 s60, 61440
  buffer_load_dwordx4 v16, s[44:47], s60 offen lds
  s_mov_b32 m0, 65536
  s_mov_b32 s60, 65536
  buffer_load_dwordx4 v16, s[44:47], s60 offen lds
  s_mov_b32 m0, 69632
  s_mov_b32 s60, 69632
  buffer_load_dwordx4 v16, s[44:47], s60 offen lds
  s_mov_b32 m0, 73728
  s_mov_b32 s60, 73728
  buffer_load_dwordx4 v16, s[44:47], s60 offen lds
  s_mov_b32 m0, 77824
  s_mov_b32 s60, 77824
  buffer_load_dwordx4 v16, s[44:47], s60 offen lds
  s_mov_b32 m0, 81920
  s_mov_b32 s60, 81920
  buffer_load_dwordx4 v16, s[44:47], s60 offen lds
  s_mov_b32 m0, 86016
  s_mov_b32 s60, 86016
  buffer_load_dwordx4 v16, s[44:47], s60 offen lds
  s_mov_b32 m0, 90112
  s_mov_b32 s60, 90112
  buffer_load_dwordx4 v16, s[44:47], s60 offen lds
  s_mov_b32 m0, 92160
  s_mov_b32 s60, 92160
  buffer_load_dwordx4 v16, s[44:47], s60 offen lds
  s_mov_b32 m0, 96256
  s_mov_b32 s60, 96256
  buffer_load_dwordx4 v16, s[44:47], s60 offen lds
  s_mov_b32 m0, 100352
  s_mov_b32 s60, 100352
  buffer_load_dwordx4 v16, s[44:47], s60 offen lds
  s_mov_b32 m0, 104448
  s_mov_b32 s60, 104448
  buffer_load_dwordx4 v16, s[44:47], s60 offen lds
  s_mov_b32 m0, 108544
  s_mov_b32 s60, 108544
  buffer_load_dwordx4 v16, s[44:47], s60 offen lds
  s_mov_b32 m0, 112640
  s_mov_b32 s60, 112640
  buffer_load_dwordx4 v16, s[44:47], s60 offen lds
  s_mov_b32 m0, 116736
  s_mov_b32 s60, 116736
  buffer_load_dwordx4 v16, s[44:47], s60 offen lds
  s_mov_b32 m0, 120832
  s_mov_b32 s60, 120832
  buffer_load_dwordx4 v16, s[44:47], s60 offen lds
  s_mov_b32 m0, 122880
  s_mov_b32 s60, 122880
  buffer_load_dwordx4 v16, s[44:47], s60 offen lds
  s_mov_b32 m0, 126976
  s_mov_b32 s60, 126976
  buffer_load_dwordx4 v16, s[44:47], s60 offen lds
  s_mov_b32 m0, 131072
  s_mov_b32 s60, 131072
  buffer_load_dwordx4 v16, s[44:47], s60 offen lds
  s_mov_b32 m0, 135168
  s_mov_b32 s60, 135168
  buffer_load_dwordx4 v16, s[44:47], s60 offen lds
  s_mov_b32 m0, 139264
  s_mov_b32 s60, 139264
  buffer_load_dwordx4 v16, s[44:47], s60 offen lds
  s_mov_b32 m0, 143360
  s_mov_b32 s60, 143360
  buffer_load_dwordx4 v16, s[44:47], s60 offen lds
  s_mov_b32 m0, 147456
  s_mov_b32 s60, 147456
  buffer_load_dwordx4 v16, s[44:47], s60 offen lds
  s_mov_b32 m0, 151552
  s_mov_b32 s60, 151552
  buffer_load_dwordx4 v16, s[44:47], s60 offen lds
  s_mov_b32 s60, 153600
  buffer_load_dwordx4 v[32:35], v16, s[44:47], s60 offen
  s_mov_b32 s60, 157696
  buffer_load_dwordx4 v[36:39], v16, s[44:47], s60 offen
  s_mov_b32 s60, 161792
  buffer_load_dwordx4 v[40:43], v16, s[44:47], s60 offen
  s_mov_b32 s60, 165888
  buffer_load_dwordx4 v[44:47], v16, s[44:47], s60 offen
  s_mov_b32 s60, 169984
  buffer_load_dwordx4 v[48:51], v16, s[44:47], s60 offen
  s_mov_b32 s60, 174080
  buffer_load_dwordx4 v[52:55], v16, s[44:47], s60 offen
  s_mov_b32 s60, 178176
  buffer_load_dwordx4 v[56:59], v16, s[44:47], s60 offen
  s_mov_b32 s60, 182272
  buffer_load_dwordx4 v[60:63], v16, s[44:47], s60 offen
  s_mov_b32 s60, 184320
  buffer_load_dwordx4 v[64:67], v16, s[44:47], s60 offen
  s_mov_b32 s60, 188416
  buffer_load_dwordx4 v[68:71], v16, s[44:47], s60 offen
  s_mov_b32 s60, 192512
  buffer_load_dwordx4 v[72:75], v16, s[44:47], s60 offen
  s_mov_b32 s60, 196608
  buffer_load_dwordx4 v[76:79], v16, s[44:47], s60 offen
  s_mov_b32 s60, 200704
  buffer_load_dwordx4 v[80:83], v16, s[44:47], s60 offen
  s_mov_b32 s60, 204800
  buffer_load_dwordx4 v[84:87], v16, s[44:47], s60 offen
  s_mov_b32 s60, 208896
  buffer_load_dwordx4 v[88:91], v16, s[44:47], s60 offen
  s_mov_b32 s60, 212992
  buffer_load_dwordx4 v[92:95], v16, s[44:47], s60 offen
  s_mov_b32 s60, 215040
  buffer_load_dwordx4 v[96:99], v16, s[44:47], s60 offen
  s_mov_b32 s60, 219136
  buffer_load_dwordx4 v[100:103], v16, s[44:47], s60 offen
  s_mov_b32 s60, 223232
  buffer_load_dwordx4 v[104:107], v16, s[44:47], s60 offen
  s_mov_b32 s60, 227328
  buffer_load_dwordx4 v[108:111], v16, s[44:47], s60 offen
  s_mov_b32 s60, 231424
  buffer_load_dwordx4 v[112:115], v16, s[44:47], s60 offen
  s_mov_b32 s60, 235520
  buffer_load_dwordx4 v[116:119], v16, s[44:47], s60 offen
  s_mov_b32 s60, 239616
  buffer_load_dwordx4 v[120:123], v16, s[44:47], s60 offen
  s_mov_b32 s60, 243712
  buffer_load_dwordx4 v[124:127], v16, s[44:47], s60 offen
  v_lshlrev_b32 v26, 4, v1
  s_waitcnt vmcnt(56)
  s_barrier
  s_mov_b32 m0, 153600
  s_mov_b32 s60, 0
  buffer_load_dwordx4 v24, s[20:23], s60 offen lds
  s_mov_b32 m0, 157696
  s_mov_b32 s60, 131072
  buffer_load_dwordx4 v24, s[20:23], s60 offen lds
  s_mov_b32 m0, 161792
  s_mov_b32 s60, 262144
  buffer_load_dwordx4 v24, s[20:23], s60 offen lds
  s_waitcnt vmcnt(51)
  s_barrier
  s_waitcnt vmcnt(19)
  v_add_u32 v27, 0, v26
  ds_write_b128 v27, v[32:35]
  v_add_u32 v27, 4096, v26
  ds_write_b128 v27, v[36:39]
  v_add_u32 v27, 8192, v26
  ds_write_b128 v27, v[40:43]
  v_add_u32 v27, 12288, v26
  ds_write_b128 v27, v[44:47]
  v_add_u32 v27, 16384, v26
  ds_write_b128 v27, v[48:51]
  v_add_u32 v27, 20480, v26
  ds_write_b128 v27, v[52:55]
  v_add_u32 v27, 24576, v26
  ds_write_b128 v27, v[56:59]
  v_add_u32 v27, 28672, v26
  ds_write_b128 v27, v[60:63]
  s_barrier
  s_waitcnt vmcnt(11)
  v_add_u32 v27, 30720, v26
  ds_write_b128 v27, v[64:67]
  v_add_u32 v27, 34816, v26
  ds_write_b128 v27, v[68:71]
  v_add_u32 v27, 38912, v26
  ds_write_b128 v27, v[72:75]
  v_add_u32 v27, 43008, v26
  ds_write_b128 v27, v[76:79]
  v_add_u32 v27, 47104, v26
  ds_write_b128 v27, v[80:83]
  v_add_u32 v27, 51200, v26
  ds_write_b128 v27, v[84:87]
  v_add_u32 v27, 55296, v26
  ds_write_b128 v27, v[88:91]
  v_add_u32 v27, 59392, v26
  ds_write_b128 v27, v[92:95]
  s_barrier
  s_waitcnt vmcnt(3)
  v_add_u32 v27, 61440, v26
  ds_write_b128 v27, v[96:99]
  v_add_u32 v27, 65536, v26
  ds_write_b128 v27, v[100:103]
  v_add_u32 v27, 69632, v26
  ds_write_b128 v27, v[104:107]
  v_add_u32 v27, 73728, v26
  ds_write_b128 v27, v[108:111]
  v_add_u32 v27, 77824, v26
  ds_write_b128 v27, v[112:115]
  v_add_u32 v27, 81920, v26
  ds_write_b128 v27, v[116:119]
  v_add_u32 v27, 86016, v26
  ds_write_b128 v27, v[120:123]
  v_add_u32 v27, 90112, v26
  ds_write_b128 v27, v[124:127]
  s_barrier
  s_waitcnt lgkmcnt(0)
  s_barrier
  s_waitcnt lgkmcnt(0)
  s_waitcnt vmcnt(0)
  s_barrier
  s_waitcnt lgkmcnt(0)
  s_barrier
  s_barrier
  s_endpgm
KB_L1:
  s_cmp_eq_u32 s39, 1
  s_cbranch_scc0 KB_L2
  s_mov_b32 m0, 4096
  s_mov_b32 s60, 65536
  buffer_load_dwordx4 v10, s[20:23], s60 offen lds
  s_mov_b32 m0, 5120
  s_mov_b32 s60, 81920
  buffer_load_dwordx4 v11, s[20:23], s60 offen lds
  s_mov_b32 m0, 6144
  s_mov_b32 s60, 98304
  buffer_load_dwordx4 v10, s[20:23], s60 offen lds
  s_mov_b32 m0, 7168
  s_mov_b32 s60, 114688
  buffer_load_dwordx4 v11, s[20:23], s60 offen lds
  s_mov_b32 m0, 19456
  s_mov_b32 s60, 3072
  buffer_load_dwordx4 v12, s[12:15], s60 offen lds
  s_mov_b32 m0, 20480
  s_mov_b32 s60, 4096
  buffer_load_dwordx4 v12, s[12:15], s60 offen lds
  s_mov_b32 m0, 21504
  s_mov_b32 s60, 5120
  buffer_load_dwordx4 v12, s[12:15], s60 offen lds
  v_lshrrev_b32 v5, 3, v1
  v_and_b32 v6, 7, v1
  v_lshlrev_b32 v5, 12, v5
  v_lshl_add_u32 v5, v6, 4, v5
  s_mul_i32 s60, s37, 80
  s_lshl_b32 s60, s60, 12
  s_lshl_b32 s61, s38, 7
  s_add_u32 s60, s60, s61
  v_add_u32 v24, s60, v5
  s_mov_b32 m0, 34816
  s_mov_b32 s60, 327680
  buffer_load_dwordx4 v10, s[20:23], s60 offen lds
  s_mov_b32 m0, 35840
  s_mov_b32 s60, 344064
  buffer_load_dwordx4 v11, s[20:23], s60 offen lds
  s_mov_b32 m0, 36864
  s_mov_b32 s60, 360448
  buffer_load_dwordx4 v10, s[20:23], s60 offen lds
  s_mov_b32 m0, 37888
  s_mov_b32 s60, 376832
  buffer_load_dwordx4 v11, s[20:23], s60 offen lds
  s_mov_b32 m0, 50176
  s_mov_b32 s60, 15360
  buffer_load_dwordx4 v12, s[12:15], s60 offen lds
  s_mov_b32 m0, 51200
  s_mov_b32 s60, 16384
  buffer_load_dwordx4 v12, s[12:15], s60 offen lds
  s_mov_b32 m0, 52224
  s_mov_b32 s60, 17408
  buffer_load_dwordx4 v12, s[12:15], s60 offen lds
  s_waitcnt vmcnt(7)
  s_barrier
  s_mov_b32 m0, 65536
  s_mov_b32 s60, 589824
  buffer_load_dwordx4 v10, s[20:23], s60 offen lds
  s_mov_b32 m0, 66560
  s_mov_b32 s60, 606208
  buffer_load_dwordx4 v11, s[20:23], s60 offen lds
  s_mov_b32 m0, 67584
  s_mov_b32 s60, 622592
  buffer_load_dwordx4 v10, s[20:23], s60 offen lds
  s_mov_b32 m0, 68608
  s_mov_b32 s60, 638976
  buffer_load_dwordx4 v11, s[20:23], s60 offen lds
  s_mov_b32 m0, 80896
  s_mov_b32 s60, 27648
  buffer_load_dwordx4 v12, s[12:15], s60 offen lds
  s_mov_b32 m0, 81920
  s_mov_b32 s60, 28672
  buffer_load_dwordx4 v12, s[12:15], s60 offen lds
  s_mov_b32 m0, 82944
  s_mov_b32 s60, 29696
  buffer_load_dwordx4 v12, s[12:15], s60 offen lds
  s_waitcnt vmcnt(7)
  s_barrier
  s_mov_b32 m0, 96256
  s_mov_b32 s60, 851968
  buffer_load_dwordx4 v10, s[20:23], s60 offen lds
  s_mov_b32 m0, 97280
  s_mov_b32 s60, 868352
  buffer_load_dwordx4 v11, s[20:23], s60 offen lds
  s_mov_b32 m0, 98304
  s_mov_b32 s60, 884736
  buffer_load_dwordx4 v10, s[20:23], s60 offen lds
  s_mov_b32 m0, 99328
  s_mov_b32 s60, 901120
  buffer_load_dwordx4 v11, s[20:23], s60 offen lds
  s_mov_b32 m0, 111616
  s_mov_b32 s60, 39936
  buffer_load_dwordx4 v12, s[12:15], s60 offen lds
  s_mov_b32 m0, 112640
  s_mov_b32 s60, 40960
  buffer_load_dwordx4 v12, s[12:15], s60 offen lds
  s_mov_b32 m0, 113664
  s_mov_b32 s60, 41984
  buffer_load_dwordx4 v12, s[12:15], s60 offen lds
  s_waitcnt vmcnt(7)
  s_barrier
  s_mov_b32 m0, 126976
  s_mov_b32 s60, 1114112
  buffer_load_dwordx4 v10, s[20:23], s60 offen lds
  s_mov_b32 m0, 128000
  s_mov_b32 s60, 1130496
  buffer_load_dwordx4 v11, s[20:23], s60 offen lds
  s_mov_b32 m0, 129024
  s_mov_b32 s60, 1146880
  buffer_load_dwordx4 v10, s[20:23], s60 offen lds
  s_mov_b32 m0, 130048
  s_mov_b32 s60, 1163264
  buffer_load_dwordx4 v11, s[20:23], s60 offen lds
  s_mov_b32 m0, 142336
  s_mov_b32 s60, 52224
  buffer_load_dwordx4 v12, s[12:15], s60 offen lds
  s_mov_b32 m0, 143360
  s_mov_b32 s60, 53248
  buffer_load_dwordx4 v12, s[12:15], s60 offen lds
  s_mov_b32 m0, 144384
  s_mov_b32 s60, 54272
  buffer_load_dwordx4 v12, s[12:15], s60 offen lds
  s_waitcnt vmcnt(7)
  s_barrier
  s_mov_b32 m0, 4096
  s_mov_b32 s60, 1376256
  buffer_load_dwordx4 v10, s[20:23], s60 offen lds
  s_mov_b32 m0, 5120
  s_mov_b32 s60, 1392640
  buffer_load_dwordx4 v11, s[20:23], s60 offen lds
  s_mov_b32 m0, 6144
  s_mov_b32 s60, 1409024
  buffer_load_dwordx4 v10, s[20:23], s60 offen lds
  s_mov_b32 m0, 7168
  s_mov_b32 s60, 1425408
  buffer_load_dwordx4 v11, s[20:23], s60 offen lds
  s_mov_b32 m0, 19456
  s_mov_b32 s60, 64512
  buffer_load_dwordx4 v12, s[12:15], s60 offen lds
  s_mov_b32 m0, 20480
  s_mov_b32 s60, 65536
  buffer_load_dwordx4 v12, s[12:15], s60 offen lds
  s_mov_b32 m0, 21504
  s_mov_b32 s60, 66560
  buffer_load_dwordx4 v12, s[12:15], s60 offen lds
  s_waitcnt vmcnt(7)
  s_barrier
  s_mov_b32 m0, 34816
  s_mov_b32 s60, 1638400
  buffer_load_dwordx4 v10, s[20:23], s60 offen lds
  s_mov_b32 m0, 35840
  s_mov_b32 s60, 1654784
  buffer_load_dwordx4 v11, s[20:23], s60 offen lds
  s_mov_b32 m0, 36864
  s_mov_b32 s60, 1671168
  buffer_load_dwordx4 v10, s[20:23], s60 offen lds
  s_mov_b32 m0, 37888
  s_mov_b32 s60, 1687552
  buffer_load_dwordx4 v11, s[20:23], s60 offen lds
  s_mov_b32 m0, 50176
  s_mov_b32 s60, 76800
  buffer_load_dwordx4 v12, s[12:15], s60 offen lds
  s_mov_b32 m0, 51200
  s_mov_b32 s60, 77824
  buffer_load_dwordx4 v12, s[12:15], s60 offen lds
  s_mov_b32 m0, 52224
  s_mov_b32 s60, 78848
  buffer_load_dwordx4 v12, s[12:15], s60 offen lds
  s_waitcnt vmcnt(7)
  s_barrier
  s_mov_b32 m0, 65536
  s_mov_b32 s60, 1900544
  buffer_load_dwordx4 v10, s[20:23], s60 offen lds
  s_mov_b32 m0, 66560
  s_mov_b32 s60, 1916928
  buffer_load_dwordx4 v11, s[20:23], s60 offen lds
  s_mov_b32 m0, 67584
  s_mov_b32 s60, 1933312
  buffer_load_dwordx4 v10, s[20:23], s60 offen lds
  s_mov_b32 m0, 68608
  s_mov_b32 s60, 1949696
  buffer_load_dwordx4 v11, s[20:23], s60 offen lds
  s_mov_b32 m0, 80896
  s_mov_b32 s60, 89088
  buffer_load_dwordx4 v12, s[12:15], s60 offen lds
  s_mov_b32 m0, 81920
  s_mov_b32 s60, 90112
  buffer_load_dwordx4 v12, s[12:15], s60 offen lds
  s_mov_b32 m0, 82944
  s_mov_b32 s60, 91136
  buffer_load_dwordx4 v12, s[12:15], s60 offen lds
  s_waitcnt vmcnt(7)
  s_barrier
  s_mov_b32 m0, 96256
  s_mov_b32 s60, 2162688
  buffer_load_dwordx4 v10, s[20:23], s60 offen lds
  s_mov_b32 m0, 97280
  s_mov_b32 s60, 2179072
  buffer_load_dwordx4 v11, s[20:23], s60 offen lds
  s_mov_b32 m0, 98304
  s_mov_b32 s60, 2195456
  buffer_load_dwordx4 v10, s[20:23], s60 offen lds
  s_mov_b32 m0, 99328
  s_mov_b32 s60, 2211840
  buffer_load_dwordx4 v11, s[20:23], s60 offen lds
  s_mov_b32 m0, 111616
  s_mov_b32 s60, 101376
  buffer_load_dwordx4 v12, s[12:15], s60 offen lds
  s_mov_b32 m0, 112640
  s_mov_b32 s60, 102400
  buffer_load_dwordx4 v12, s[12:15], s60 offen lds
  s_mov_b32 m0, 113664
  s_mov_b32 s60, 103424
  buffer_load_dwordx4 v12, s[12:15], s60 offen lds
  s_waitcnt vmcnt(7)
  s_barrier
  s_mov_b32 m0, 126976
  s_mov_b32 s60, 2424832
  buffer_load_dwordx4 v10, s[20:23], s60 offen lds
  s_mov_b32 m0, 128000
  s_mov_b32 s60, 2441216
  buffer_load_dwordx4 v11, s[20:23], s60 offen lds
  s_mov_b32 m0, 129024
  s_mov_b32 s60, 2457600
  buffer_load_dwordx4 v10, s[20:23], s60 offen lds
  s_mov_b32 m0, 130048
  s_mov_b32 s60, 2473984
  buffer_load_dwordx4 v11, s[20:23], s60 offen lds
  s_mov_b32 m0, 142336
  s_mov_b32 s60, 113664
  buffer_load_dwordx4 v12, s[12:15], s60 offen lds
  s_mov_b32 m0, 143360
  s_mov_b32 s60, 114688
  buffer_load_dwordx4 v12, s[12:15], s60 offen lds
  s_mov_b32 m0, 144384
  s_mov_b32 s60, 115712
  buffer_load_dwordx4 v12, s[12:15], s60 offen lds
  s_waitcnt vmcnt(7)
  s_barrier
  s_mov_b32 m0, 1024
  s_mov_b32 s60, 1024
  buffer_load_dwordx4 v16, s[44:47], s60 offen lds
  s_mov_b32 m0, 5120
  s_mov_b32 s60, 5120
  buffer_load_dwordx4 v16, s[44:47], s60 offen lds
  s_mov_b32 m0, 9216
  s_mov_b32 s60, 9216
  buffer_load_dwordx4 v16, s[44:47], s60 offen lds
  s_mov_b32 m0, 13312
  s_mov_b32 s60, 13312
  buffer_load_dwordx4 v16, s[44:47], s60 offen lds
  s_mov_b32 m0, 17408
  s_mov_b32 s60, 17408
  buffer_load_dwordx4 v16, s[44:47], s60 offen lds
  s_mov_b32 m0, 21504
  s_mov_b32 s60, 21504
  buffer_load_dwordx4 v16, s[44:47], s60 offen lds
  s_mov_b32 m0, 25600
  s_mov_b32 s60, 25600
  buffer_load_dwordx4 v16, s[44:47], s60 offen lds
  s_mov_b32 m0, 29696
  s_mov_b32 s60, 29696
  buffer_load_dwordx4 v16, s[44:47], s60 offen lds
  s_waitcnt vmcnt(8)
  s_barrier
  s_mov_b32 m0, 31744
  s_mov_b32 s60, 31744
  buffer_load_dwordx4 v16, s[44:47], s60 offen lds
  s_mov_b32 m0, 35840
  s_mov_b32 s60, 35840
  buffer_load_dwordx4 v16, s[44:47], s60 offen lds
  s_mov_b32 m0, 39936
  s_mov_b32 s60, 39936
  buffer_load_dwordx4 v16, s[44:47], s60 offen lds
  s_mov_b32 m0, 44032
  s_mov_b32 s60, 44032
  buffer_load_dwordx4 v16, s[44:47], s60 offen lds
  s_mov_b32 m0, 48128
  s_mov_b32 s60, 48128
  buffer_load_dwordx4 v16, s[44:47], s60 offen lds
  s_mov_b32 m0, 52224
  s_mov_b32 s60, 52224
  buffer_load_dwordx4 v16, s[44:47], s60 offen lds
  s_mov_b32 m0, 56320
  s_mov_b32 s60, 56320
  buffer_load_dwordx4 v16, s[44:47], s60 offen lds
  s_mov_b32 m0, 60416
  s_mov_b32 s60, 60416
  buffer_load_dwordx4 v16, s[44:47], s60 offen lds
  s_barrier
  s_mov_b32 m0, 62464
  s_mov_b32 s60, 62464
  buffer_load_dwordx4 v16, s[44:47], s60 offen lds
  s_mov_b32 m0, 66560
  s_mov_b32 s60, 66560
  buffer_load_dwordx4 v16, s[44:47], s60 offen lds
  s_mov_b32 m0, 70656
  s_mov_b32 s60, 70656
  buffer_load_dwordx4 v16, s[44:47], s60 offen lds
  s_mov_b32 m0, 74752
  s_mov_b32 s60, 74752
  buffer_load_dwordx4 v16, s[44:47], s60 offen lds
  s_mov_b32 m0, 78848
  s_mov_b32 s60, 78848
  buffer_load_dwordx4 v16, s[44:47], s60 offen lds
  s_mov_b32 m0, 82944
  s_mov_b32 s60, 82944
  buffer_load_dwordx4 v16, s[44:47], s60 offen lds
  s_mov_b32 m0, 87040
  s_mov_b32 s60, 87040
  buffer_load_dwordx4 v16, s[44:47], s60 offen lds
  s_mov_b32 m0, 91136
  s_mov_b32 s60, 91136
  buffer_load_dwordx4 v16, s[44:47], s60 offen lds
  s_mov_b32 m0, 93184
  s_mov_b32 s60, 93184
  buffer_load_dwordx4 v16, s[44:47], s60 offen lds
  s_mov_b32 m0, 97280
  s_mov_b32 s60, 97280
  buffer_load_dwordx4 v16, s[44:47], s60 offen lds
  s_mov_b32 m0, 101376
  s_mov_b32 s60, 101376
  buffer_load_dwordx4 v16, s[44:47], s60 offen lds
  s_mov_b32 m0, 105472
  s_mov_b32 s60, 105472
  buffer_load_dwordx4 v16, s[44:47], s60 offen lds
  s_mov_b32 m0, 109568
  s_mov_b32 s60, 109568
  buffer_load_dwordx4 v16, s[44:47], s60 offen lds
  s_mov_b32 m0, 113664
  s_mov_b32 s60, 113664
  buffer_load_dwordx4 v16, s[44:47], s60 offen lds
  s_mov_b32 m0, 117760
  s_mov_b32 s60, 117760
  buffer_load_dwordx4 v16, s[44:47], s60 offen lds
  s_mov_b32 m0, 121856
  s_mov_b32 s60, 121856
  buffer_load_dwordx4 v16, s[44:47], s60 offen lds
  s_mov_b32 m0, 123904
  s_mov_b32 s60, 123904
  buffer_load_dwordx4 v16, s[44:47], s60 offen lds
  s_mov_b32 m0, 128000
  s_mov_b32 s60, 128000
  buffer_load_dwordx4 v16, s[44:47], s60 offen lds
  s_mov_b32 m0, 132096
  s_mov_b32 s60, 132096
  buffer_load_dwordx4 v16, s[44:47], s60 offen lds
  s_mov_b32 m0, 136192
  s_mov_b32 s60, 136192
  buffer_load_dwordx4 v16, s[44:47], s60 offen lds
  s_mov_b32 m0, 140288
  s_mov_b32 s60, 140288
  buffer_load_dwordx4 v16, s[44:47], s60 offen lds
  s_mov_b32 m0, 144384
  s_mov_b32 s60, 144384
  buffer_load_dwordx4 v16, s[44:47], s60 offen lds
  s_mov_b32 m0, 148480
  s_mov_b32 s60, 148480
  buffer_load_dwordx4 v16, s[44:47], s60 offen lds
  s_mov_b32 m0, 152576
  s_mov_b32 s60, 152576
  buffer_load_dwordx4 v16, s[44:47], s60 offen lds
  s_mov_b32 s60, 154624
  buffer_load_dwordx4 v[32:35], v16, s[44:47], s60 offen
  s_mov_b32 s60, 158720
  buffer_load_dwordx4 v[36:39], v16, s[44:47], s60 offen
  s_mov_b32 s60, 162816
  buffer_load_dwordx4 v[40:43], v16, s[44:47], s60 offen
  s_mov_b32 s60, 166912
  buffer_load_dwordx4 v[44:47], v16, s[44:47], s60 offen
  s_mov_b32 s60, 171008
  buffer_load_dwordx4 v[48:51], v16, s[44:47], s60 offen
  s_mov_b32 s60, 175104
  buffer_load_dwordx4 v[52:55], v16, s[44:47], s60 offen
  s_mov_b32 s60, 179200
  buffer_load_dwordx4 v[56:59], v16, s[44:47], s60 offen
  s_mov_b32 s60, 183296
  buffer_load_dwordx4 v[60:63], v16, s[44:47], s60 offen
  s_mov_b32 s60, 185344
  buffer_load_dwordx4 v[64:67], v16, s[44:47], s60 offen
  s_mov_b32 s60, 189440
  buffer_load_dwordx4 v[68:71], v16, s[44:47], s60 offen
  s_mov_b32 s60, 193536
  buffer_load_dwordx4 v[72:75], v16, s[44:47], s60 offen
  s_mov_b32 s60, 197632
  buffer_load_dwordx4 v[76:79], v16, s[44:47], s60 offen
  s_mov_b32 s60, 201728
  buffer_load_dwordx4 v[80:83], v16, s[44:47], s60 offen
  s_mov_b32 s60, 205824
  buffer_load_dwordx4 v[84:87], v16, s[44:47], s60 offen
  s_mov_b32 s60, 209920
  buffer_load_dwordx4 v[88:91], v16, s[44:47], s60 offen
  s_mov_b32 s60, 214016
  buffer_load_dwordx4 v[92:95], v16, s[44:47], s60 offen
  s_mov_b32 s60, 216064
  buffer_load_dwordx4 v[96:99], v16, s[44:47], s60 offen
  s_mov_b32 s60, 220160
  buffer_load_dwordx4 v[100:103], v16, s[44:47], s60 offen
  s_mov_b32 s60, 224256
  buffer_load_dwordx4 v[104:107], v16, s[44:47], s60 offen
  s_mov_b32 s60, 228352
  buffer_load_dwordx4 v[108:111], v16, s[44:47], s60 offen
  s_mov_b32 s60, 232448
  buffer_load_dwordx4 v[112:115], v16, s[44:47], s60 offen
  s_mov_b32 s60, 236544
  buffer_load_dwordx4 v[116:119], v16, s[44:47], s60 offen
  s_mov_b32 s60, 240640
  buffer_load_dwordx4 v[120:123], v16, s[44:47], s60 offen
  s_mov_b32 s60, 244736
  buffer_load_dwordx4 v[124:127], v16, s[44:47], s60 offen
  v_lshlrev_b32 v26, 4, v1
  s_waitcnt vmcnt(56)
  s_barrier
  s_mov_b32 m0, 154624
  s_mov_b32 s60, 32768
  buffer_load_dwordx4 v24, s[20:23], s60 offen lds
  s_mov_b32 m0, 158720
  s_mov_b32 s60, 163840
  buffer_load_dwordx4 v24, s[20:23], s60 offen lds
  s_mov_b32 m0, 162816
  s_mov_b32 s60, 294912
  buffer_load_dwordx4 v24, s[20:23], s60 offen lds
  s_waitcnt vmcnt(51)
  s_barrier
  s_waitcnt vmcnt(19)
  v_add_u32 v27, 1024, v26
  ds_write_b128 v27, v[32:35]
  v_add_u32 v27, 5120, v26
  ds_write_b128 v27, v[36:39]
  v_add_u32 v27, 9216, v26
  ds_write_b128 v27, v[40:43]
  v_add_u32 v27, 13312, v26
  ds_write_b128 v27, v[44:47]
  v_add_u32 v27, 17408, v26
  ds_write_b128 v27, v[48:51]
  v_add_u32 v27, 21504, v26
  ds_write_b128 v27, v[52:55]
  v_add_u32 v27, 25600, v26
  ds_write_b128 v27, v[56:59]
  v_add_u32 v27, 29696, v26
  ds_write_b128 v27, v[60:63]
  s_barrier
  s_waitcnt vmcnt(11)
  v_add_u32 v27, 31744, v26
  ds_write_b128 v27, v[64:67]
  v_add_u32 v27, 35840, v26
  ds_write_b128 v27, v[68:71]
  v_add_u32 v27, 39936, v26
  ds_write_b128 v27, v[72:75]
  v_add_u32 v27, 44032, v26
  ds_write_b128 v27, v[76:79]
  v_add_u32 v27, 48128, v26
  ds_write_b128 v27, v[80:83]
  v_add_u32 v27, 52224, v26
  ds_write_b128 v27, v[84:87]
  v_add_u32 v27, 56320, v26
  ds_write_b128 v27, v[88:91]
  v_add_u32 v27, 60416, v26
  ds_write_b128 v27, v[92:95]
  s_barrier
  s_waitcnt vmcnt(3)
  v_add_u32 v27, 62464, v26
  ds_write_b128 v27, v[96:99]
  v_add_u32 v27, 66560, v26
  ds_write_b128 v27, v[100:103]
  v_add_u32 v27, 70656, v26
  ds_write_b128 v27, v[104:107]
  v_add_u32 v27, 74752, v26
  ds_write_b128 v27, v[108:111]
  v_add_u32 v27, 78848, v26
  ds_write_b128 v27, v[112:115]
  v_add_u32 v27, 82944, v26
  ds_write_b128 v27, v[116:119]
  v_add_u32 v27, 87040, v26
  ds_write_b128 v27, v[120:123]
  v_add_u32 v27, 91136, v26
  ds_write_b128 v27, v[124:127]
  s_barrier
  s_waitcnt lgkmcnt(0)
  s_barrier
  s_waitcnt lgkmcnt(0)
  s_waitcnt vmcnt(0)
  s_barrier
  s_waitcnt lgkmcnt(0)
  s_barrier
  s_barrier
  s_endpgm
KB_L2:
  s_cmp_eq_u32 s39, 2
  s_cbranch_scc0 KB_L3
  s_mov_b32 m0, 8192
  s_mov_b32 s60, 131072
  buffer_load_dwordx4 v10, s[20:23], s60 offen lds
  s_mov_b32 m0, 9216
  s_mov_b32 s60, 147456
  buffer_load_dwordx4 v11, s[20:23], s60 offen lds
  s_mov_b32 m0, 10240
  s_mov_b32 s60, 163840
  buffer_load_dwordx4 v10, s[20:23], s60 offen lds
  s_mov_b32 m0, 11264
  s_mov_b32 s60, 180224
  buffer_load_dwordx4 v11, s[20:23], s60 offen lds
  s_mov_b32 m0, 22528
  s_mov_b32 s60, 6144
  buffer_load_dwordx4 v12, s[12:15], s60 offen lds
  s_mov_b32 m0, 23552
  s_mov_b32 s60, 7168
  buffer_load_dwordx4 v12, s[12:15], s60 offen lds
  s_mov_b32 m0, 24576
  s_mov_b32 s60, 8192
  buffer_load_dwordx4 v12, s[12:15], s60 offen lds
  v_lshrrev_b32 v5, 3, v1
  v_and_b32 v6, 7, v1
  v_lshlrev_b32 v5, 12, v5
  v_lshl_add_u32 v5, v6, 4, v5
  s_mul_i32 s60, s37, 80
  s_lshl_b32 s60, s60, 12
  s_lshl_b32 s61, s38, 7
  s_add_u32 s60, s60, s61
  v_add_u32 v24, s60, v5
  s_mov_b32 m0, 38912
  s_mov_b32 s60, 393216
  buffer_load_dwordx4 v10, s[20:23], s60 offen lds
  s_mov_b32 m0, 39936
  s_mov_b32 s60, 409600
  buffer_load_dwordx4 v11, s[20:23], s60 offen lds
  s_mov_b32 m0, 40960
  s_mov_b32 s60, 425984
  buffer_load_dwordx4 v10, s[20:23], s60 offen lds
  s_mov_b32 m0, 41984
  s_mov_b32 s60, 442368
  buffer_load_dwordx4 v11, s[20:23], s60 offen lds
  s_mov_b32 m0, 53248
  s_mov_b32 s60, 18432
  buffer_load_dwordx4 v12, s[12:15], s60 offen lds
  s_mov_b32 m0, 54272
  s_mov_b32 s60, 19456
  buffer_load_dwordx4 v12, s[12:15], s60 offen lds
  s_mov_b32 m0, 55296
  s_mov_b32 s60, 20480
  buffer_load_dwordx4 v12, s[12:15], s60 offen lds
  s_waitcnt vmcnt(7)
  s_barrier
  s_mov_b32 m0, 69632
  s_mov_b32 s60, 655360
  buffer_load_dwordx4 v10, s[20:23], s60 offen lds
  s_mov_b32 m0, 70656
  s_mov_b32 s60, 671744
  buffer_load_dwordx4 v11, s[20:23], s60 offen lds
  s_mov_b32 m0, 71680
  s_mov_b32 s60, 688128
  buffer_load_dwordx4 v10, s[20:23], s60 offen lds
  s_mov_b32 m0, 72704
  s_mov_b32 s60, 704512
  buffer_load_dwordx4 v11, s[20:23], s60 offen lds
  s_mov_b32 m0, 83968
  s_mov_b32 s60, 30720
  buffer_load_dwordx4 v12, s[12:15], s60 offen lds
  s_mov_b32 m0, 84992
  s_mov_b32 s60, 31744
  buffer_load_dwordx4 v12, s[12:15], s60 offen lds
  s_mov_b32 m0, 86016
  s_mov_b32 s60, 32768
  buffer_load_dwordx4 v12, s[12:15], s60 offen lds
  s_waitcnt vmcnt(7)
  s_barrier
  s_mov_b32 m0, 100352
  s_mov_b32 s60, 917504
  buffer_load_dwordx4 v10, s[20:23], s60 offen lds
  s_mov_b32 m0, 101376
  s_mov_b32 s60, 933888
  buffer_load_dwordx4 v11, s[20:23], s60 offen lds
  s_mov_b32 m0, 102400
  s_mov_b32 s60, 950272
  buffer_load_dwordx4 v10, s[20:23], s60 offen lds
  s_mov_b32 m0, 103424
  s_mov_b32 s60, 966656
  buffer_load_dwordx4 v11, s[20:23], s60 offen lds
  s_mov_b32 m0, 114688
  s_mov_b32 s60, 43008
  buffer_load_dwordx4 v12, s[12:15], s60 offen lds
  s_mov_b32 m0, 115712
  s_mov_b32 s60, 44032
  buffer_load_dwordx4 v12, s[12:15], s60 offen lds
  s_mov_b32 m0, 116736
  s_mov_b32 s60, 45056
  buffer_load_dwordx4 v12, s[12:15], s60 offen lds
  s_waitcnt vmcnt(7)
  s_barrier
  s_mov_b32 m0, 131072
  s_mov_b32 s60, 1179648
  buffer_load_dwordx4 v10, s[20:23], s60 offen lds
  s_mov_b32 m0, 132096
  s_mov_b32 s60, 1196032
  buffer_load_dwordx4 v11, s[20:23], s60 offen lds
  s_mov_b32 m0, 133120
  s_mov_b32 s60, 1212416
  buffer_load_dwordx4 v10, s[20:23], s60 offen lds
  s_mov_b32 m0, 134144
  s_mov_b32 s60, 1228800
  buffer_load_dwordx4 v11, s[20:23], s60 offen lds
  s_mov_b32 m0, 145408
  s_mov_b32 s60, 55296
  buffer_load_dwordx4 v12, s[12:15], s60 offen lds
  s_mov_b32 m0, 146432
  s_mov_b32 s60, 56320
  buffer_load_dwordx4 v12, s[12:15], s60 offen lds
  s_mov_b32 m0, 147456
  s_mov_b32 s60, 57344
  buffer_load_dwordx4 v12, s[12:15], s60 offen lds
  s_waitcnt vmcnt(7)
  s_barrier
  s_mov_b32 m0, 8192
  s_mov_b32 s60, 1441792
  buffer_load_dwordx4 v10, s[20:23], s60 offen lds
  s_mov_b32 m0, 9216
  s_mov_b32 s60, 1458176
  buffer_load_dwordx4 v11, s[20:23], s60 offen lds
  s_mov_b32 m0, 10240
  s_mov_b32 s60, 1474560
  buffer_load_dwordx4 v10, s[20:23], s60 offen lds
  s_mov_b32 m0, 11264
  s_mov_b32 s60, 1490944
  buffer_load_dwordx4 v11, s[20:23], s60 offen lds
  s_mov_b32 m0, 22528
  s_mov_b32 s60, 67584
  buffer_load_dwordx4 v12, s[12:15], s60 offen lds
  s_mov_b32 m0, 23552
  s_mov_b32 s60, 68608
  buffer_load_dwordx4 v12, s[12:15], s60 offen lds
  s_mov_b32 m0, 24576
  s_mov_b32 s60, 69632
  buffer_load_dwordx4 v12, s[12:15], s60 offen lds
  s_waitcnt vmcnt(7)
  s_barrier
  s_mov_b32 m0, 38912
  s_mov_b32 s60, 1703936
  buffer_load_dwordx4 v10, s[20:23], s60 offen lds
  s_mov_b32 m0, 39936
  s_mov_b32 s60, 1720320
  buffer_load_dwordx4 v11, s[20:23], s60 offen lds
  s_mov_b32 m0, 40960
  s_mov_b32 s60, 1736704
  buffer_load_dwordx4 v10, s[20:23], s60 offen lds
  s_mov_b32 m0, 41984
  s_mov_b32 s60, 1753088
  buffer_load_dwordx4 v11, s[20:23], s60 offen lds
  s_mov_b32 m0, 53248
  s_mov_b32 s60, 79872
  buffer_load_dwordx4 v12, s[12:15], s60 offen lds
  s_mov_b32 m0, 54272
  s_mov_b32 s60, 80896
  buffer_load_dwordx4 v12, s[12:15], s60 offen lds
  s_mov_b32 m0, 55296
  s_mov_b32 s60, 81920
  buffer_load_dwordx4 v12, s[12:15], s60 offen lds
  s_waitcnt vmcnt(7)
  s_barrier
  s_mov_b32 m0, 69632
  s_mov_b32 s60, 1966080
  buffer_load_dwordx4 v10, s[20:23], s60 offen lds
  s_mov_b32 m0, 70656
  s_mov_b32 s60, 1982464
  buffer_load_dwordx4 v11, s[20:23], s60 offen lds
  s_mov_b32 m0, 71680
  s_mov_b32 s60, 1998848
  buffer_load_dwordx4 v10, s[20:23], s60 offen lds
  s_mov_b32 m0, 72704
  s_mov_b32 s60, 2015232
  buffer_load_dwordx4 v11, s[20:23], s60 offen lds
  s_mov_b32 m0, 83968
  s_mov_b32 s60, 92160
  buffer_load_dwordx4 v12, s[12:15], s60 offen lds
  s_mov_b32 m0, 84992
  s_mov_b32 s60, 93184
  buffer_load_dwordx4 v12, s[12:15], s60 offen lds
  s_mov_b32 m0, 86016
  s_mov_b32 s60, 94208
  buffer_load_dwordx4 v12, s[12:15], s60 offen lds
  s_waitcnt vmcnt(7)
  s_barrier
  s_mov_b32 m0, 100352
  s_mov_b32 s60, 2228224
  buffer_load_dwordx4 v10, s[20:23], s60 offen lds
  s_mov_b32 m0, 101376
  s_mov_b32 s60, 2244608
  buffer_load_dwordx4 v11, s[20:23], s60 offen lds
  s_mov_b32 m0, 102400
  s_mov_b32 s60, 2260992
  buffer_load_dwordx4 v10, s[20:23], s60 offen lds
  s_mov_b32 m0, 103424
  s_mov_b32 s60, 2277376
  buffer_load_dwordx4 v11, s[20:23], s60 offen lds
  s_mov_b32 m0, 114688
  s_mov_b32 s60, 104448
  buffer_load_dwordx4 v12, s[12:15], s60 offen lds
  s_mov_b32 m0, 115712
  s_mov_b32 s60, 105472
  buffer_load_dwordx4 v12, s[12:15], s60 offen lds
  s_mov_b32 m0, 116736
  s_mov_b32 s60, 106496
  buffer_load_dwordx4 v12, s[12:15], s60 offen lds
  s_waitcnt vmcnt(7)
  s_barrier
  s_mov_b32 m0, 131072
  s_mov_b32 s60, 2490368
  buffer_load_dwordx4 v10, s[20:23], s60 offen lds
  s_mov_b32 m0, 132096
  s_mov_b32 s60, 2506752
  buffer_load_dwordx4 v11, s[20:23], s60 offen lds
  s_mov_b32 m0, 133120
  s_mov_b32 s60, 2523136
  buffer_load_dwordx4 v10, s[20:23], s60 offen lds
  s_mov_b32 m0, 134144
  s_mov_b32 s60, 2539520
  buffer_load_dwordx4 v11, s[20:23], s60 offen lds
  s_mov_b32 m0, 145408
  s_mov_b32 s60, 116736
  buffer_load_dwordx4 v12, s[12:15], s60 offen lds
  s_mov_b32 m0, 146432
  s_mov_b32 s60, 117760
  buffer_load_dwordx4 v12, s[12:15], s60 offen lds
  s_mov_b32 m0, 147456
  s_mov_b32 s60, 118784
  buffer_load_dwordx4 v12, s[12:15], s60 offen lds
  s_waitcnt vmcnt(7)
  s_barrier
  s_mov_b32 m0, 2048
  s_mov_b32 s60, 2048
  buffer_load_dwordx4 v16, s[44:47], s60 offen lds
  s_mov_b32 m0, 6144
  s_mov_b32 s60, 6144
  buffer_load_dwordx4 v16, s[44:47], s60 offen lds
  s_mov_b32 m0, 10240
  s_mov_b32 s60, 10240
  buffer_load_dwordx4 v16, s[44:47], s60 offen lds
  s_mov_b32 m0, 14336
  s_mov_b32 s60, 14336
  buffer_load_dwordx4 v16, s[44:47], s60 offen lds
  s_mov_b32 m0, 18432
  s_mov_b32 s60, 18432
  buffer_load_dwordx4 v16, s[44:47], s60 offen lds
  s_mov_b32 m0, 22528
  s_mov_b32 s60, 22528
  buffer_load_dwordx4 v16, s[44:47], s60 offen lds
  s_mov_b32 m0, 26624
  s_mov_b32 s60, 26624
  buffer_load_dwordx4 v16, s[44:47], s60 offen lds
  s_waitcnt vmcnt(7)
  s_barrier
  s_mov_b32 m0, 32768
  s_mov_b32 s60, 32768
  buffer_load_dwordx4 v16, s[44:47], s60 offen lds
  s_mov_b32 m0, 36864
  s_mov_b32 s60, 36864
  buffer_load_dwordx4 v16, s[44:47], s60 offen lds
  s_mov_b32 m0, 40960
  s_mov_b32 s60, 40960
  buffer_load_dwordx4 v16, s[44:47], s60 offen lds
  s_mov_b32 m0, 45056
  s_mov_b32 s60, 45056
  buffer_load_dwordx4 v16, s[44:47], s60 offen lds
  s_mov_b32 m0, 49152
  s_mov_b32 s60, 49152
  buffer_load_dwordx4 v16, s[44:47], s60 offen lds
  s_mov_b32 m0, 53248
  s_mov_b32 s60, 53248
  buffer_load_dwordx4 v16, s[44:47], s60 offen lds
  s_mov_b32 m0, 57344
  s_mov_b32 s60, 57344
  buffer_load_dwordx4 v16, s[44:47], s60 offen lds
  s_barrier
  s_mov_b32 m0, 63488
  s_mov_b32 s60, 63488
  buffer_load_dwordx4 v16, s[44:47], s60 offen lds
  s_mov_b32 m0, 67584
  s_mov_b32 s60, 67584
  buffer_load_dwordx4 v16, s[44:47], s60 offen lds
  s_mov_b32 m0, 71680
  s_mov_b32 s60, 71680
  buffer_load_dwordx4 v16, s[44:47], s60 offen lds
  s_mov_b32 m0, 75776
  s_mov_b32 s60, 75776
  buffer_load_dwordx4 v16, s[44:47], s60 offen lds
  s_mov_b32 m0, 79872
  s_mov_b32 s60, 79872
  buffer_load_dwordx4 v16, s[44:47], s60 offen lds
  s_mov_b32 m0, 83968
  s_mov_b32 s60, 83968
  buffer_load_dwordx4 v16, s[44:47], s60 offen lds
  s_mov_b32 m0, 88064
  s_mov_b32 s60, 88064
  buffer_load_dwordx4 v16, s[44:47], s60 offen lds
  s_mov_b32 m0, 94208
  s_mov_b32 s60, 94208
  buffer_load_dwordx4 v16, s[44:47], s60 offen lds
  s_mov_b32 m0, 98304
  s_mov_b32 s60, 98304
  buffer_load_dwordx4 v16, s[44:47], s60 offen lds
  s_mov_b32 m0, 102400
  s_mov_b32 s60, 102400
  buffer_load_dwordx4 v16, s[44:47], s60 offen lds
  s_mov_b32 m0, 106496
  s_mov_b32 s60, 106496
  buffer_load_dwordx4 v16, s[44:47], s60 offen lds
  s_mov_b32 m0, 110592
  s_mov_b32 s60, 110592
  buffer_load_dwordx4 v16, s[44:47], s60 offen lds
  s_mov_b32 m0, 114688
  s_mov_b32 s60, 114688
  buffer_load_dwordx4 v16, s[44:47], s60 offen lds
  s_mov_b32 m0, 118784
  s_mov_b32 s60, 118784
  buffer_load_dwordx4 v16, s[44:47], s60 offen lds
  s_mov_b32 m0, 124928
  s_mov_b32 s60, 124928
  buffer_load_dwordx4 v16, s[44:47], s60 offen lds
  s_mov_b32 m0, 129024
  s_mov_b32 s60, 129024
  buffer_load_dwordx4 v16, s[44:47], s60 offen lds
  s_mov_b32 m0, 133120
  s_mov_b32 s60, 133120
  buffer_load_dwordx4 v16, s[44:47], s60 offen lds
  s_mov_b32 m0, 137216
  s_mov_b32 s60, 137216
  buffer_load_dwordx4 v16, s[44:47], s60 offen lds
  s_mov_b32 m0, 141312
  s_mov_b32 s60, 141312
  buffer_load_dwordx4 v16, s[44:47], s60 offen lds
  s_mov_b32 m0, 145408
  s_mov_b32 s60, 145408
  buffer_load_dwordx4 v16, s[44:47], s60 offen lds
  s_mov_b32 m0, 149504
  s_mov_b32 s60, 149504
  buffer_load_dwordx4 v16, s[44:47], s60 offen lds
  s_mov_b32 s60, 155648
  buffer_load_dwordx4 v[32:35], v16, s[44:47], s60 offen
  s_mov_b32 s60, 159744
  buffer_load_dwordx4 v[36:39], v16, s[44:47], s60 offen
  s_mov_b32 s60, 163840
  buffer_load_dwordx4 v[40:43], v16, s[44:47], s60 offen
  s_mov_b32 s60, 167936
  buffer_load_dwordx4 v[44:47], v16, s[44:47], s60 offen
  s_mov_b32 s60, 172032
  buffer_load_dwordx4 v[48:51], v16, s[44:47], s60 offen
  s_mov_b32 s60, 176128
  buffer_load_dwordx4 v[52:55], v16, s[44:47], s60 offen
  s_mov_b32 s60, 180224
  buffer_load_dwordx4 v[56:59], v16, s[44:47], s60 offen
  s_mov_b32 s60, 186368
  buffer_load_dwordx4 v[64:67], v16, s[44:47], s60 offen
  s_mov_b32 s60, 190464
  buffer_load_dwordx4 v[68:71], v16, s[44:47], s60 offen
  s_mov_b32 s60, 194560
  buffer_load_dwordx4 v[72:75], v16, s[44:47], s60 offen
  s_mov_b32 s60, 198656
  buffer_load_dwordx4 v[76:79], v16, s[44:47], s60 offen
  s_mov_b32 s60, 202752
  buffer_load_dwordx4 v[80:83], v16, s[44:47], s60 offen
  s_mov_b32 s60, 206848
  buffer_load_dwordx4 v[84:87], v16, s[44:47], s60 offen
  s_mov_b32 s60, 210944
  buffer_load_dwordx4 v[88:91], v16, s[44:47], s60 offen
  s_mov_b32 s60, 217088
  buffer_load_dwordx4 v[96:99], v16, s[44:47], s60 offen
  s_mov_b32 s60, 221184
  buffer_load_dwordx4 v[100:103], v16, s[44:47], s60 offen
  s_mov_b32 s60, 225280
  buffer_load_dwordx4 v[104:107], v16, s[44:47], s60 offen
  s_mov_b32 s60, 229376
  buffer_load_dwordx4 v[108:111], v16, s[44:47], s60 offen
  s_mov_b32 s60, 233472
  buffer_load_dwordx4 v[112:115], v16, s[44:47], s60 offen
  s_mov_b32 s60, 237568
  buffer_load_dwordx4 v[116:119], v16, s[44:47], s60 offen
  s_mov_b32 s60, 241664
  buffer_load_dwordx4 v[120:123], v16, s[44:47], s60 offen
  v_lshlrev_b32 v26, 4, v1
  s_waitcnt vmcnt(49)
  s_barrier
  s_mov_b32 m0, 155648
  s_mov_b32 s60, 65536
  buffer_load_dwordx4 v24, s[20:23], s60 offen lds
  s_mov_b32 m0, 159744
  s_mov_b32 s60, 196608
  buffer_load_dwordx4 v24, s[20:23], s60 offen lds
  s_waitcnt vmcnt(44)
  s_barrier
  s_waitcnt vmcnt(16)
  v_add_u32 v27, 2048, v26
  ds_write_b128 v27, v[32:35]
  v_add_u32 v27, 6144, v26
  ds_write_b128 v27, v[36:39]
  v_add_u32 v27, 10240, v26
  ds_write_b128 v27, v[40:43]
  v_add_u32 v27, 14336, v26
  ds_write_b128 v27, v[44:47]
  v_add_u32 v27, 18432, v26
  ds_write_b128 v27, v[48:51]
  v_add_u32 v27, 22528, v26
  ds_write_b128 v27, v[52:55]
  v_add_u32 v27, 26624, v26
  ds_write_b128 v27, v[56:59]
  s_barrier
  s_waitcnt vmcnt(9)
  v_add_u32 v27, 32768, v26
  ds_write_b128 v27, v[64:67]
  v_add_u32 v27, 36864, v26
  ds_write_b128 v27, v[68:71]
  v_add_u32 v27, 40960, v26
  ds_write_b128 v27, v[72:75]
  v_add_u32 v27, 45056, v26
  ds_write_b128 v27, v[76:79]
  v_add_u32 v27, 49152, v26
  ds_write_b128 v27, v[80:83]
  v_add_u32 v27, 53248, v26
  ds_write_b128 v27, v[84:87]
  v_add_u32 v27, 57344, v26
  ds_write_b128 v27, v[88:91]
  s_barrier
  s_waitcnt vmcnt(2)
  v_add_u32 v27, 63488, v26
  ds_write_b128 v27, v[96:99]
  v_add_u32 v27, 67584, v26
  ds_write_b128 v27, v[100:103]
  v_add_u32 v27, 71680, v26
  ds_write_b128 v27, v[104:107]
  v_add_u32 v27, 75776, v26
  ds_write_b128 v27, v[108:111]
  v_add_u32 v27, 79872, v26
  ds_write_b128 v27, v[112:115]
  v_add_u32 v27, 83968, v26
  ds_write_b128 v27, v[116:119]
  v_add_u32 v27, 88064, v26
  ds_write_b128 v27, v[120:123]
  s_barrier
  s_waitcnt lgkmcnt(0)
  s_barrier
  s_waitcnt lgkmcnt(0)
  s_waitcnt vmcnt(0)
  s_barrier
  s_waitcnt lgkmcnt(0)
  s_barrier
  s_barrier
  s_endpgm
KB_L3:
  s_mov_b32 m0, 12288
  s_mov_b32 s60, 196608
  buffer_load_dwordx4 v10, s[20:23], s60 offen lds
  s_mov_b32 m0, 13312
  s_mov_b32 s60, 212992
  buffer_load_dwordx4 v11, s[20:23], s60 offen lds
  s_mov_b32 m0, 14336
  s_mov_b32 s60, 229376
  buffer_load_dwordx4 v10, s[20:23], s60 offen lds
  s_mov_b32 m0, 15360
  s_mov_b32 s60, 245760
  buffer_load_dwordx4 v11, s[20:23], s60 offen lds
  s_mov_b32 m0, 25600
  s_mov_b32 s60, 9216
  buffer_load_dwordx4 v12, s[12:15], s60 offen lds
  s_mov_b32 m0, 26624
  s_mov_b32 s60, 10240
  buffer_load_dwordx4 v12, s[12:15], s60 offen lds
  s_mov_b32 m0, 27648
  s_mov_b32 s60, 11264
  buffer_load_dwordx4 v12, s[12:15], s60 offen lds
  v_lshrrev_b32 v5, 3, v1
  v_and_b32 v6, 7, v1
  v_lshlrev_b32 v5, 12, v5
  v_lshl_add_u32 v5, v6, 4, v5
  s_mul_i32 s60, s37, 80
  s_lshl_b32 s60, s60, 12
  s_lshl_b32 s61, s38, 7
  s_add_u32 s60, s60, s61
  v_add_u32 v24, s60, v5
  s_mov_b32 m0, 43008
  s_mov_b32 s60, 458752
  buffer_load_dwordx4 v10, s[20:23], s60 offen lds
  s_mov_b32 m0, 44032
  s_mov_b32 s60, 475136
  buffer_load_dwordx4 v11, s[20:23], s60 offen lds
  s_mov_b32 m0, 45056
  s_mov_b32 s60, 491520
  buffer_load_dwordx4 v10, s[20:23], s60 offen lds
  s_mov_b32 m0, 46080
  s_mov_b32 s60, 507904
  buffer_load_dwordx4 v11, s[20:23], s60 offen lds
  s_mov_b32 m0, 56320
  s_mov_b32 s60, 21504
  buffer_load_dwordx4 v12, s[12:15], s60 offen lds
  s_mov_b32 m0, 57344
  s_mov_b32 s60, 22528
  buffer_load_dwordx4 v12, s[12:15], s60 offen lds
  s_mov_b32 m0, 58368
  s_mov_b32 s60, 23552
  buffer_load_dwordx4 v12, s[12:15], s60 offen lds
  s_waitcnt vmcnt(7)
  s_barrier
  s_mov_b32 m0, 73728
  s_mov_b32 s60, 720896
  buffer_load_dwordx4 v10, s[20:23], s60 offen lds
  s_mov_b32 m0, 74752
  s_mov_b32 s60, 737280
  buffer_load_dwordx4 v11, s[20:23], s60 offen lds
  s_mov_b32 m0, 75776
  s_mov_b32 s60, 753664
  buffer_load_dwordx4 v10, s[20:23], s60 offen lds
  s_mov_b32 m0, 76800
  s_mov_b32 s60, 770048
  buffer_load_dwordx4 v11, s[20:23], s60 offen lds
  s_mov_b32 m0, 87040
  s_mov_b32 s60, 33792
  buffer_load_dwordx4 v12, s[12:15], s60 offen lds
  s_mov_b32 m0, 88064
  s_mov_b32 s60, 34816
  buffer_load_dwordx4 v12, s[12:15], s60 offen lds
  s_mov_b32 m0, 89088
  s_mov_b32 s60, 35840
  buffer_load_dwordx4 v12, s[12:15], s60 offen lds
  s_waitcnt vmcnt(7)
  s_barrier
  s_mov_b32 m0, 104448
  s_mov_b32 s60, 983040
  buffer_load_dwordx4 v10, s[20:23], s60 offen lds
  s_mov_b32 m0, 105472
  s_mov_b32 s60, 999424
  buffer_load_dwordx4 v11, s[20:23], s60 offen lds
  s_mov_b32 m0, 106496
  s_mov_b32 s60, 1015808
  buffer_load_dwordx4 v10, s[20:23], s60 offen lds
  s_mov_b32 m0, 107520
  s_mov_b32 s60, 1032192
  buffer_load_dwordx4 v11, s[20:23], s60 offen lds
  s_mov_b32 m0, 117760
  s_mov_b32 s60, 46080
  buffer_load_dwordx4 v12, s[12:15], s60 offen lds
  s_mov_b32 m0, 118784
  s_mov_b32 s60, 47104
  buffer_load_dwordx4 v12, s[12:15], s60 offen lds
  s_mov_b32 m0, 119808
  s_mov_b32 s60, 48128
  buffer_load_dwordx4 v12, s[12:15], s60 offen lds
  s_waitcnt vmcnt(7)
  s_barrier
  s_mov_b32 m0, 135168
  s_mov_b32 s60, 1245184
  buffer_load_dwordx4 v10, s[20:23], s60 offen lds
  s_mov_b32 m0, 136192
  s_mov_b32 s60, 1261568
  buffer_load_dwordx4 v11, s[20:23], s60 offen lds
  s_mov_b32 m0, 137216
  s_mov_b32 s60, 1277952
  buffer_load_dwordx4 v10, s[20:23], s60 offen lds
  s_mov_b32 m0, 138240
  s_mov_b32 s60, 1294336
  buffer_load_dwordx4 v11, s[20:23], s60 offen lds
  s_mov_b32 m0, 148480
  s_mov_b32 s60, 58368
  buffer_load_dwordx4 v12, s[12:15], s60 offen lds
  s_mov_b32 m0, 149504
  s_mov_b32 s60, 59392
  buffer_load_dwordx4 v12, s[12:15], s60 offen lds
  s_mov_b32 m0, 150528
  s_mov_b32 s60, 60416
  buffer_load_dwordx4 v12, s[12:15], s60 offen lds
  s_waitcnt vmcnt(7)
  s_barrier
  s_mov_b32 m0, 12288
  s_mov_b32 s60, 1507328
  buffer_load_dwordx4 v10, s[20:23], s60 offen lds
  s_mov_b32 m0, 13312
  s_mov_b32 s60, 1523712
  buffer_load_dwordx4 v11, s[20:23], s60 offen lds
  s_mov_b32 m0, 14336
  s_mov_b32 s60, 1540096
  buffer_load_dwordx4 v10, s[20:23], s60 offen lds
  s_mov_b32 m0, 15360
  s_mov_b32 s60, 1556480
  buffer_load_dwordx4 v11, s[20:23], s60 offen lds
  s_mov_b32 m0, 25600
  s_mov_b32 s60, 70656
  buffer_load_dwordx4 v12, s[12:15], s60 offen lds
  s_mov_b32 m0, 26624
  s_mov_b32 s60, 71680
  buffer_load_dwordx4 v12, s[12:15], s60 offen lds
  s_mov_b32 m0, 27648
  s_mov_b32 s60, 72704
  buffer_load_dwordx4 v12, s[12:15], s60 offen lds
  s_waitcnt vmcnt(7)
  s_barrier
  s_mov_b32 m0, 43008
  s_mov_b32 s60, 1769472
  buffer_load_dwordx4 v10, s[20:23], s60 offen lds
  s_mov_b32 m0, 44032
  s_mov_b32 s60, 1785856
  buffer_load_dwordx4 v11, s[20:23], s60 offen lds
  s_mov_b32 m0, 45056
  s_mov_b32 s60, 1802240
  buffer_load_dwordx4 v10, s[20:23], s60 offen lds
  s_mov_b32 m0, 46080
  s_mov_b32 s60, 1818624
  buffer_load_dwordx4 v11, s[20:23], s60 offen lds
  s_mov_b32 m0, 56320
  s_mov_b32 s60, 82944
  buffer_load_dwordx4 v12, s[12:15], s60 offen lds
  s_mov_b32 m0, 57344
  s_mov_b32 s60, 83968
  buffer_load_dwordx4 v12, s[12:15], s60 offen lds
  s_mov_b32 m0, 58368
  s_mov_b32 s60, 84992
  buffer_load_dwordx4 v12, s[12:15], s60 offen lds
  s_waitcnt vmcnt(7)
  s_barrier
  s_mov_b32 m0, 73728
  s_mov_b32 s60, 2031616
  buffer_load_dwordx4 v10, s[20:23], s60 offen lds
  s_mov_b32 m0, 74752
  s_mov_b32 s60, 2048000
  buffer_load_dwordx4 v11, s[20:23], s60 offen lds
  s_mov_b32 m0, 75776
  s_mov_b32 s60, 2064384
  buffer_load_dwordx4 v10, s[20:23], s60 offen lds
  s_mov_b32 m0, 76800
  s_mov_b32 s60, 2080768
  buffer_load_dwordx4 v11, s[20:23], s60 offen lds
  s_mov_b32 m0, 87040
  s_mov_b32 s60, 95232
  buffer_load_dwordx4 v12, s[12:15], s60 offen lds
  s_mov_b32 m0, 88064
  s_mov_b32 s60, 96256
  buffer_load_dwordx4 v12, s[12:15], s60 offen lds
  s_mov_b32 m0, 89088
  s_mov_b32 s60, 97280
  buffer_load_dwordx4 v12, s[12:15], s60 offen lds
  s_waitcnt vmcnt(7)
  s_barrier
  s_mov_b32 m0, 104448
  s_mov_b32 s60, 2293760
  buffer_load_dwordx4 v10, s[20:23], s60 offen lds
  s_mov_b32 m0, 105472
  s_mov_b32 s60, 2310144
  buffer_load_dwordx4 v11, s[20:23], s60 offen lds
  s_mov_b32 m0, 106496
  s_mov_b32 s60, 2326528
  buffer_load_dwordx4 v10, s[20:23], s60 offen lds
  s_mov_b32 m0, 107520
  s_mov_b32 s60, 2342912
  buffer_load_dwordx4 v11, s[20:23], s60 offen lds
  s_mov_b32 m0, 117760
  s_mov_b32 s60, 107520
  buffer_load_dwordx4 v12, s[12:15], s60 offen lds
  s_mov_b32 m0, 118784
  s_mov_b32 s60, 108544
  buffer_load_dwordx4 v12, s[12:15], s60 offen lds
  s_mov_b32 m0, 119808
  s_mov_b32 s60, 109568
  buffer_load_dwordx4 v12, s[12:15], s60 offen lds
  s_waitcnt vmcnt(7)
  s_barrier
  s_mov_b32 m0, 135168
  s_mov_b32 s60, 2555904
  buffer_load_dwordx4 v10, s[20:23], s60 offen lds
  s_mov_b32 m0, 136192
  s_mov_b32 s60, 2572288
  buffer_load_dwordx4 v11, s[20:23], s60 offen lds
  s_mov_b32 m0, 137216
  s_mov_b32 s60, 2588672
  buffer_load_dwordx4 v10, s[20:23], s60 offen lds
  s_mov_b32 m0, 138240
  s_mov_b32 s60, 2605056
  buffer_load_dwordx4 v11, s[20:23], s60 offen lds
  s_mov_b32 m0, 148480
  s_mov_b32 s60, 119808
  buffer_load_dwordx4 v12, s[12:15], s60 offen lds
  s_mov_b32 m0, 149504
  s_mov_b32 s60, 120832
  buffer_load_dwordx4 v12, s[12:15], s60 offen lds
  s_mov_b32 m0, 150528
  s_mov_b32 s60, 121856
  buffer_load_dwordx4 v12, s[12:15], s60 offen lds
  s_waitcnt vmcnt(7)
  s_barrier
  s_mov_b32 m0, 3072
  s_mov_b32 s60, 3072
  buffer_load_dwordx4 v16, s[44:47], s60 offen lds
  s_mov_b32 m0, 7168
  s_mov_b32 s60, 7168
  buffer_load_dwordx4 v16, s[44:47], s60 offen lds
  s_mov_b32 m0, 11264
  s_mov_b32 s60, 11264
  buffer_load_dwordx4 v16, s[44:47], s60 offen lds
  s_mov_b32 m0, 15360
  s_mov_b32 s60, 15360
  buffer_load_dwordx4 v16, s[44:47], s60 offen lds
  s_mov_b32 m0, 19456
  s_mov_b32 s60, 19456
  buffer_load_dwordx4 v16, s[44:47], s60 offen lds
  s_mov_b32 m0, 23552
  s_mov_b32 s60, 23552
  buffer_load_dwordx4 v16, s[44:47], s60 offen lds
  s_mov_b32 m0, 27648
  s_mov_b32 s60, 27648
  buffer_load_dwordx4 v16, s[44:47], s60 offen lds
  s_waitcnt vmcnt(7)
  s_barrier
  s_mov_b32 m0, 33792
  s_mov_b32 s60, 33792
  buffer_load_dwordx4 v16, s[44:47], s60 offen lds
  s_mov_b32 m0, 37888
  s_mov_b32 s60, 37888
  buffer_load_dwordx4 v16, s[44:47], s60 offen lds
  s_mov_b32 m0, 41984
  s_mov_b32 s60, 41984
  buffer_load_dwordx4 v16, s[44:47], s60 offen lds
  s_mov_b32 m0, 46080
  s_mov_b32 s60, 46080
  buffer_load_dwordx4 v16, s[44:47], s60 offen lds
  s_mov_b32 m0, 50176
  s_mov_b32 s60, 50176
  buffer_load_dwordx4 v16, s[44:47], s60 offen lds
  s_mov_b32 m0, 54272
  s_mov_b32 s60, 54272
  buffer_load_dwordx4 v16, s[44:47], s60 offen lds
  s_mov_b32 m0, 58368
  s_mov_b32 s60, 58368
  buffer_load_dwordx4 v16, s[44:47], s60 offen lds
  s_barrier
  s_mov_b32 m0, 64512
  s_mov_b32 s60, 64512
  buffer_load_dwordx4 v16, s[44:47], s60 offen lds
  s_mov_b32 m0, 68608
  s_mov_b32 s60, 68608
  buffer_load_dwordx4 v16, s[44:47], s60 offen lds
  s_mov_b32 m0, 72704
  s_mov_b32 s60, 72704
  buffer_load_dwordx4 v16, s[44:47], s60 offen lds
  s_mov_b32 m0, 76800
  s_mov_b32 s60, 76800
  buffer_load_dwordx4 v16, s[44:47], s60 offen lds
  s_mov_b32 m0, 80896
  s_mov_b32 s60, 80896
  buffer_load_dwordx4 v16, s[44:47], s60 offen lds
  s_mov_b32 m0, 84992
  s_mov_b32 s60, 84992
  buffer_load_dwordx4 v16, s[44:47], s60 offen lds
  s_mov_b32 m0, 89088
  s_mov_b32 s60, 89088
  buffer_load_dwordx4 v16, s[44:47], s60 offen lds
  s_mov_b32 m0, 95232
  s_mov_b32 s60, 95232
  buffer_load_dwordx4 v16, s[44:47], s60 offen lds
  s_mov_b32 m0, 99328
  s_mov_b32 s60, 99328
  buffer_load_dwordx4 v16, s[44:47], s60 offen lds
  s_mov_b32 m0, 103424
  s_mov_b32 s60, 103424
  buffer_load_dwordx4 v16, s[44:47], s60 offen lds
  s_mov_b32 m0, 107520
  s_mov_b32 s60, 107520
  buffer_load_dwordx4 v16, s[44:47], s60 offen lds
  s_mov_b32 m0, 111616
  s_mov_b32 s60, 111616
  buffer_load_dwordx4 v16, s[44:47], s60 offen lds
  s_mov_b32 m0, 115712
  s_mov_b32 s60, 115712
  buffer_load_dwordx4 v16, s[44:47], s60 offen lds
  s_mov_b32 m0, 119808
  s_mov_b32 s60, 119808
  buffer_load_dwordx4 v16, s[44:47], s60 offen lds
  s_mov_b32 m0, 125952
  s_mov_b32 s60, 125952
  buffer_load_dwordx4 v16, s[44:47], s60 offen lds
  s_mov_b32 m0, 130048
  s_mov_b32 s60, 130048
  buffer_load_dwordx4 v16, s[44:47], s60 offen lds
  s_mov_b32 m0, 134144
  s_mov_b32 s60, 134144
  buffer_load_dwordx4 v16, s[44:47], s60 offen lds
  s_mov_b32 m0, 138240
  s_mov_b32 s60, 138240
  buffer_load_dwordx4 v16, s[44:47], s60 offen lds
  s_mov_b32 m0, 142336
  s_mov_b32 s60, 142336
  buffer_load_dwordx4 v16, s[44:47], s60 offen lds
  s_mov_b32 m0, 146432
  s_mov_b32 s60, 146432
  buffer_load_dwordx4 v16, s[44:47], s60 offen lds
  s_mov_b32 m0, 150528
  s_mov_b32 s60, 150528
  buffer_load_dwordx4 v16, s[44:47], s60 offen lds
  s_mov_b32 s60, 156672
  buffer_load_dwordx4 v[32:35], v16, s[44:47], s60 offen
  s_mov_b32 s60, 160768
  buffer_load_dwordx4 v[36:39], v16, s[44:47], s60 offen
  s_mov_b32 s60, 164864
  buffer_load_dwordx4 v[40:43], v16, s[44:47], s60 offen
  s_mov_b32 s60, 168960
  buffer_load_dwordx4 v[44:47], v16, s[44:47], s60 offen
  s_mov_b32 s60, 173056
  buffer_load_dwordx4 v[48:51], v16, s[44:47], s60 offen
  s_mov_b32 s60, 177152
  buffer_load_dwordx4 v[52:55], v16, s[44:47], s60 offen
  s_mov_b32 s60, 181248
  buffer_load_dwordx4 v[56:59], v16, s[44:47], s60 offen
  s_mov_b32 s60, 187392
  buffer_load_dwordx4 v[64:67], v16, s[44:47], s60 offen
  s_mov_b32 s60, 191488
  buffer_load_dwordx4 v[68:71], v16, s[44:47], s60 offen
  s_mov_b32 s60, 195584
  buffer_load_dwordx4 v[72:75], v16, s[44:47], s60 offen
  s_mov_b32 s60, 199680
  buffer_load_dwordx4 v[76:79], v16, s[44:47], s60 offen
  s_mov_b32 s60, 203776
  buffer_load_dwordx4 v[80:83], v16, s[44:47], s60 offen
  s_mov_b32 s60, 207872
  buffer_load_dwordx4 v[84:87], v16, s[44:47], s60 offen
  s_mov_b32 s60, 211968
  buffer_load_dwordx4 v[88:91], v16, s[44:47], s60 offen
  s_mov_b32 s60, 218112
  buffer_load_dwordx4 v[96:99], v16, s[44:47], s60 offen
  s_mov_b32 s60, 222208
  buffer_load_dwordx4 v[100:103], v16, s[44:47], s60 offen
  s_mov_b32 s60, 226304
  buffer_load_dwordx4 v[104:107], v16, s[44:47], s60 offen
  s_mov_b32 s60, 230400
  buffer_load_dwordx4 v[108:111], v16, s[44:47], s60 offen
  s_mov_b32 s60, 234496
  buffer_load_dwordx4 v[112:115], v16, s[44:47], s60 offen
  s_mov_b32 s60, 238592
  buffer_load_dwordx4 v[116:119], v16, s[44:47], s60 offen
  s_mov_b32 s60, 242688
  buffer_load_dwordx4 v[120:123], v16, s[44:47], s60 offen
  v_lshlrev_b32 v26, 4, v1
  s_waitcnt vmcnt(49)
  s_barrier
  s_mov_b32 m0, 156672
  s_mov_b32 s60, 98304
  buffer_load_dwordx4 v24, s[20:23], s60 offen lds
  s_mov_b32 m0, 160768
  s_mov_b32 s60, 229376
  buffer_load_dwordx4 v24, s[20:23], s60 offen lds
  s_waitcnt vmcnt(44)
  s_barrier
  s_waitcnt vmcnt(16)
  v_add_u32 v27, 3072, v26
  ds_write_b128 v27, v[32:35]
  v_add_u32 v27, 7168, v26
  ds_write_b128 v27, v[36:39]
  v_add_u32 v27, 11264, v26
  ds_write_b128 v27, v[40:43]
  v_add_u32 v27, 15360, v26
  ds_write_b128 v27, v[44:47]
  v_add_u32 v27, 19456, v26
  ds_write_b128 v27, v[48:51]
  v_add_u32 v27, 23552, v26
  ds_write_b128 v27, v[52:55]
  v_add_u32 v27, 27648, v26
  ds_write_b128 v27, v[56:59]
  s_barrier
  s_waitcnt vmcnt(9)
  v_add_u32 v27, 33792, v26
  ds_write_b128 v27, v[64:67]
  v_add_u32 v27, 37888, v26
  ds_write_b128 v27, v[68:71]
  v_add_u32 v27, 41984, v26
  ds_write_b128 v27, v[72:75]
  v_add_u32 v27, 46080, v26
  ds_write_b128 v27, v[76:79]
  v_add_u32 v27, 50176, v26
  ds_write_b128 v27, v[80:83]
  v_add_u32 v27, 54272, v26
  ds_write_b128 v27, v[84:87]
  v_add_u32 v27, 58368, v26
  ds_write_b128 v27, v[88:91]
  s_barrier
  s_waitcnt vmcnt(2)
  v_add_u32 v27, 64512, v26
  ds_write_b128 v27, v[96:99]
  v_add_u32 v27, 68608, v26
  ds_write_b128 v27, v[100:103]
  v_add_u32 v27, 72704, v26
  ds_write_b128 v27, v[104:107]
  v_add_u32 v27, 76800, v26
  ds_write_b128 v27, v[108:111]
  v_add_u32 v27, 80896, v26
  ds_write_b128 v27, v[112:115]
  v_add_u32 v27, 84992, v26
  ds_write_b128 v27, v[116:119]
  v_add_u32 v27, 89088, v26
  ds_write_b128 v27, v[120:123]
  s_barrier
  s_waitcnt lgkmcnt(0)
  s_barrier
  s_waitcnt lgkmcnt(0)
  s_waitcnt vmcnt(0)
  s_barrier
  s_waitcnt lgkmcnt(0)
  s_barrier
  s_barrier
  s_endpgm
KB_END:
  s_endpgm
.set CODE_LEN, ((KB_END - ka_kernel) / 16) * 16
.set CODE_Q, ((CODE_LEN / 4 + 15) / 16) * 16
.set KB_LEN, ((KB_END - kb_kernel) / 16) * 16
.section .rodata,"a"
.p2align 6
.amdhsa_kernel ka_kernel
  .amdhsa_next_free_vgpr 160
  .amdhsa_next_free_sgpr 102
  .amdhsa_accum_offset 160
  .amdhsa_group_segment_fixed_size 0
  .amdhsa_kernarg_size 112
  .amdhsa_user_sgpr_count 2
  .amdhsa_user_sgpr_kernarg_segment_ptr 1
  .amdhsa_system_sgpr_workgroup_id_x 1
  .amdhsa_float_denorm_mode_32 3
.end_amdhsa_kernel
.amdhsa_kernel kb_kernel
  .amdhsa_next_free_vgpr 256
  .amdhsa_next_free_sgpr 96
  .amdhsa_accum_offset 196
  .amdhsa_group_segment_fixed_size 0
  .amdhsa_kernarg_size 112
  .amdhsa_user_sgpr_count 2
  .amdhsa_user_sgpr_kernarg_segment_ptr 1
  .amdhsa_system_sgpr_workgroup_id_x 1
  .amdhsa_float_denorm_mode_32 3
.end_amdhsa_kernel
```
